```python
import torch

def _softmax(x, axis=-1):
    return torch.softmax(x, dim=axis)
def _gelu(x):
    return torch.nn.functional.gelu(x, approximate="tanh")
def _silu(x):
    return torch.nn.functional.silu(x)
def _sigmoid(x):
    return torch.sigmoid(x)
def _layernorm(x, axis=-1, eps=1e-5):
    m = x.mean(dim=axis, keepdim=True)
    v = x.var(dim=axis, keepdim=True, unbiased=False)
    return (x - m) / torch.sqrt(v + eps)
def _scatter_add(tgt, idx, src, axis=0):
    return tgt.clone().index_add_(axis, idx, src)
def _segment_sum(src, seg, n):
    out = torch.zeros((n,) + src.shape[1:], dtype=src.dtype)
    return out.index_add_(0, seg, src)
def _pad(x, pw):
    flat = tuple(v for pair in reversed(pw) for v in pair)
    return torch.nn.functional.pad(x, flat)

kernel_name = 'standalone__spectral_fnet__prompt'

def setup_inputs():

    _w = (lambda a: (lambda t: t.to(torch.bfloat16) if t.is_floating_point() else t)(torch.as_tensor(a)))
    B, S, D = 1, 2048, 576
    ns = torch.arange(S)[:, None] * torch.arange(S)[None, :]
    nd = torch.arange(D)[:, None] * torch.arange(D)[None, :]
    Ws_re = torch.cos(-2.0 * torch.pi * ns / S).to(float)
    Ws_im = torch.sin(-2.0 * torch.pi * ns / S).to(float)
    Wd_re = torch.cos(-2.0 * torch.pi * nd / D).to(float)
    Wd_im = torch.sin(-2.0 * torch.pi * nd / D).to(float)
    return {
        "x": _w((lambda *s: torch.randn(*s, dtype=torch.bfloat16) * 0.05)(B, S, D)),
        "dft_seq_re": _w(Ws_re),
        "dft_seq_im": _w(Ws_im),
        "dft_hid_re": _w(Wd_re),
        "dft_hid_im": _w(Wd_im),
    }

def reference(x, dft_seq_re, dft_seq_im, dft_hid_re, dft_hid_im):
    a = torch.einsum("bsd,ed->bse", x, dft_hid_re)
    b = torch.einsum("bsd,ed->bse", x, dft_hid_im)
    y = torch.einsum("ts,bse->bte", dft_seq_re, a) - torch.einsum("ts,bse->bte", dft_seq_im, b)
    return y
```

```asm
; @launch kernel=k1_kernel grid=(1152,1,1) block=(64,1,1) lds=0
; @launch kernel=k2_kernel grid=(1152,1,1) block=(64,1,1) lds=0
.amdgcn_target "amdgcn-amd-amdhsa--gfx950"
.text
.globl k1_kernel
.p2align 8
.type k1_kernel,@function
k1_kernel:
    s_cmp_ge_u32 s2, 1152
    s_cbranch_scc1 k1_done
    s_load_dwordx2 s[4:5], s[0:1], 0
    s_load_dwordx2 s[6:7], s[0:1], 24
    s_load_dwordx2 s[8:9], s[0:1], 32
    s_load_dwordx2 s[10:11], s[0:1], 56
    s_and_b32 s12, s2, 63
    s_lshr_b32 s13, s2, 6
    s_waitcnt lgkmcnt(0)
    s_mov_b32 s16, s4
    s_mov_b32 s17, s5
    s_mov_b32 s18, 2359296
    s_mov_b32 s19, 0x20000
    s_mov_b32 s20, s6
    s_mov_b32 s21, s7
    s_mov_b32 s22, 663552
    s_mov_b32 s23, 0x20000
    s_mov_b32 s24, s8
    s_mov_b32 s25, s9
    s_mov_b32 s26, 663552
    s_mov_b32 s27, 0x20000
    s_mov_b32 s28, s10
    s_mov_b32 s29, s11
    s_mov_b32 s30, 4718592
    s_mov_b32 s31, 0x20000
    v_and_b32 v1, 31, v0
    v_lshrrev_b32 v2, 5, v0
    s_lshl_b32 s14, s12, 5
    s_lshl_b32 s15, s13, 5
    v_add_u32 v3, s14, v1
    v_add_u32 v4, s15, v1
    s_movk_i32 s3, 1152
    v_mul_lo_u32 v5, v3, s3
    v_mul_lo_u32 v6, v4, s3
    v_lshlrev_b32 v7, 4, v2
    v_add_u32 v5, v5, v7
    v_add_u32 v6, v6, v7
    .irp r,32,33,34,35,36,37,38,39,40,41,42,43,44,45,46,47,48,49,50,51,52,53,54,55,56,57,58,59,60,61,62,63
    v_mov_b32 v\r, 0
    .endr
    s_mov_b32 s3, 0
k1_loop:
    buffer_load_dwordx4 v[8:11], v5, s[16:19], s3 offen
    buffer_load_dwordx4 v[12:15], v6, s[20:23], s3 offen
    buffer_load_dwordx4 v[16:19], v6, s[24:27], s3 offen
    s_waitcnt vmcnt(0)
    v_mfma_f32_32x32x16_bf16 v[32:47], v[8:11], v[12:15], v[32:47]
    v_mfma_f32_32x32x16_bf16 v[48:63], v[8:11], v[16:19], v[48:63]
    s_add_u32 s3, s3, 32
    s_cmp_lt_u32 s3, 1152
    s_cbranch_scc1 k1_loop
    s_nop 15
    s_nop 15
    v_lshlrev_b32 v5, 12, v4
    s_lshl_b32 s14, s14, 1
    v_add_u32 v5, s14, v5
    v_lshlrev_b32 v7, 3, v2
    v_add_u32 v5, v5, v7
    .irp g,0,1,2,3
    v_cvt_pk_bf16_f32 v8, v[32+4*\g], v[33+4*\g]
    v_cvt_pk_bf16_f32 v9, v[34+4*\g], v[35+4*\g]
    v_cvt_pk_bf16_f32 v10, -v[48+4*\g], -v[49+4*\g]
    v_cvt_pk_bf16_f32 v11, -v[50+4*\g], -v[51+4*\g]
    s_mov_b32 s3, 2359296
    buffer_store_dwordx2 v[8:9], v5, s[28:31], 0 offen offset:16*\g
    buffer_store_dwordx2 v[10:11], v5, s[28:31], s3 offen offset:16*\g
    s_waitcnt vmcnt(0)
    .endr
k1_done:
    s_endpgm

.globl k2_kernel
.p2align 8
.type k2_kernel,@function
k2_kernel:
    s_cmp_ge_u32 s2, 1152
    s_cbranch_scc1 k2_done
    s_load_dwordx2 s[4:5], s[0:1], 40
    s_load_dwordx2 s[6:7], s[0:1], 8
    s_load_dwordx2 s[8:9], s[0:1], 16
    s_load_dwordx2 s[10:11], s[0:1], 56
    s_and_b32 s12, s2, 63
    s_lshr_b32 s13, s2, 6
    s_waitcnt lgkmcnt(0)
    s_mov_b32 s16, s4
    s_mov_b32 s17, s5
    s_mov_b32 s18, 2359296
    s_mov_b32 s19, 0x20000
    s_mov_b32 s20, s6
    s_mov_b32 s21, s7
    s_mov_b32 s22, 8388608
    s_mov_b32 s23, 0x20000
    s_mov_b32 s24, s8
    s_mov_b32 s25, s9
    s_mov_b32 s26, 8388608
    s_mov_b32 s27, 0x20000
    s_mov_b32 s28, s10
    s_mov_b32 s29, s11
    s_mov_b32 s30, 4718592
    s_mov_b32 s31, 0x20000
    v_and_b32 v1, 31, v0
    v_lshrrev_b32 v2, 5, v0
    s_lshl_b32 s14, s12, 5
    s_lshl_b32 s15, s13, 5
    v_add_u32 v3, s14, v1
    v_add_u32 v4, s15, v1
    v_lshlrev_b32 v5, 12, v3
    v_lshlrev_b32 v6, 12, v4
    v_lshlrev_b32 v7, 4, v2
    v_add_u32 v5, v5, v7
    v_add_u32 v6, v6, v7
    v_add_u32 v24, 2359296, v6
    .irp r,32,33,34,35,36,37,38,39,40,41,42,43,44,45,46,47
    v_mov_b32 v\r, 0
    .endr
    s_mov_b32 s3, 0
k2_loop:
    buffer_load_dwordx4 v[8:11], v6, s[28:31], s3 offen
    buffer_load_dwordx4 v[12:15], v5, s[20:23], s3 offen
    buffer_load_dwordx4 v[16:19], v24, s[28:31], s3 offen
    buffer_load_dwordx4 v[20:23], v5, s[24:27], s3 offen
    s_waitcnt vmcnt(2)
    v_mfma_f32_32x32x16_bf16 v[32:47], v[8:11], v[12:15], v[32:47]
    s_waitcnt vmcnt(0)
    v_mfma_f32_32x32x16_bf16 v[32:47], v[16:19], v[20:23], v[32:47]
    s_add_u32 s3, s3, 32
    s_cmp_lt_u32 s3, 4096
    s_cbranch_scc1 k2_loop
    s_nop 15
    s_nop 15
    s_movk_i32 s3, 1152
    v_mul_lo_u32 v5, v3, s3
    s_lshl_b32 s15, s15, 1
    v_add_u32 v5, s15, v5
    v_lshlrev_b32 v7, 3, v2
    v_add_u32 v5, v5, v7
    .irp g,0,1,2,3
    v_cvt_pk_bf16_f32 v8, v[32+4*\g], v[33+4*\g]
    v_cvt_pk_bf16_f32 v9, v[34+4*\g], v[35+4*\g]
    buffer_store_dwordx2 v[8:9], v5, s[16:19], 0 offen offset:16*\g
    s_waitcnt vmcnt(0)
    .endr
k2_done:
    s_endpgm

.section .rodata,"a"
.p2align 6
.amdhsa_kernel k1_kernel
  .amdhsa_next_free_vgpr 64
  .amdhsa_next_free_sgpr 40
  .amdhsa_accum_offset 64
  .amdhsa_group_segment_fixed_size 0
  .amdhsa_kernarg_size 64
  .amdhsa_user_sgpr_count 2
  .amdhsa_user_sgpr_kernarg_segment_ptr 1
  .amdhsa_system_sgpr_workgroup_id_x 1
.end_amdhsa_kernel
.p2align 6
.amdhsa_kernel k2_kernel
  .amdhsa_next_free_vgpr 64
  .amdhsa_next_free_sgpr 40
  .amdhsa_accum_offset 64
  .amdhsa_group_segment_fixed_size 0
  .amdhsa_kernarg_size 64
  .amdhsa_user_sgpr_count 2
  .amdhsa_user_sgpr_kernarg_segment_ptr 1
  .amdhsa_system_sgpr_workgroup_id_x 1
.end_amdhsa_kernel
```

```asm
; @launch grid=(256,1,1) block=(256,1,1) lds=41984
.amdgcn_target "amdgcn-amd-amdhsa--gfx950"
.text
.globl standalone__spectral_fnet__prompt_kernel
.p2align 8
.type standalone__spectral_fnet__prompt_kernel,@function
standalone__spectral_fnet__prompt_kernel:
    s_load_dwordx2 s[16:17], s[0:1], 0
    s_load_dwordx2 s[28:29], s[0:1], 56
    s_getpc_b64 s[32:33]
L_pc:
    s_mov_b32 s34, L_tab-L_pc
    s_mov_b32 s35, 0x20000
    v_lshlrev_b32 v4, 7, v0
    s_cmpk_ge_u32 s2, 144
    buffer_load_dword v37, v4, s[32:35], 0 offen
    s_cbranch_scc1 L_cons
    v_lshrrev_b32 v1, 3, v0
    v_readfirstlane_b32 s3, v0
    s_and_b32 s4, s2, 15
    s_lshr_b32 s5, s2, 4
    s_mulk_i32 s4, 9
    v_and_b32 v2, 7, v0
    v_bitop3_b32 v2, v2, v1, 6 bitop3:0x78
    s_add_u32 s4, s4, s5
    s_movk_i32 s5, 1152
    v_mad_u32_u24 v3, v1, s5, v2
    s_lshl_b32 s4, s4, 7
    v_lshlrev_b32 v3, 4, v3
    s_mov_b32 s18, 2359296
    s_mov_b32 s19, 0x20000
    s_lshl_b32 m0, s3, 6
    s_waitcnt lgkmcnt(0)
    buffer_load_dwordx4 v3, s[16:19], s4 offen nt lds
    s_add_u32 s4, s4, 588800
    buffer_load_dwordx4 v3, s[16:19], s4 offen offset:1024 nt lds
    s_add_u32 s4, s4, 588800
    buffer_load_dwordx4 v3, s[16:19], s4 offen offset:2048 nt lds
    s_add_u32 s4, s4, 588800
    buffer_load_dwordx4 v3, s[16:19], s4 offen offset:3072 nt lds
    s_load_dword s40, s[28:29], 524288
    s_load_dwordx2 s[20:21], s[0:1], 40
    s_load_dwordx2 s[24:25], s[0:1], 48
    v_lshlrev_b32 v5, 4, v0
    s_mul_i32 s67, s3, 48
    s_lshl_b32 s62, s3, 6
    s_add_u32 s67, s67, L_tab-L_pc
    s_add_u32 m0, s62, 16384
    s_mov_b32 s34, L_tabend-L_pc
    buffer_load_dwordx4 v5, s[32:35], s67 offen lds
    buffer_load_dwordx4 v5, s[32:35], s67 offen offset:1024 lds
    buffer_load_dwordx4 v5, s[32:35], s67 offen offset:2048 lds
    buffer_load_dwordx4 v5, s[32:35], s67 offen offset:3072 lds
    v_lshrrev_b32 v1, 2, v0
    v_lshrrev_b32 v2, 3, v0
    v_and_b32 v3, 3, v1
    v_lshlrev_b32 v4, 1, v0
    v_and_or_b32 v3, v2, 24, v3
    v_and_b32 v5, 12, v1
    v_and_or_b32 v3, v4, 4, v3
    v_and_b32 v4, 1, v0
    v_and_b32 v6, 0xcf, v0
    v_cvt_f32_u32 v3, v3
    v_cvt_f32_u32 v7, v4
    v_cvt_f32_u32 v5, v5
    v_cmp_eq_u32 vcc, 1, v6
    v_mul_f32 v3, 0x3c000000, v3
    v_mul_f32 v7, 0x3e800000, v7
    v_lshlrev_b32 v4, 4, v4
    v_cndmask_b32 v3, v3, 0.5, vcc
    v_cndmask_b32 v7, v7, 0, vcc
    v_fma_f32 v124, v3, v5, v7
    v_mul_f32 v12, 0x41800000, v3
    v_add_f32 v125, v124, v3
    v_fma_f32 v126, v3, 2.0, v124
    v_cos_f32 v8, v12
    v_add_f32 v127, v126, v3
    v_add_f32 v128, v124, v12
    v_add_f32 v129, v125, v12
    v_add_f32 v130, v126, v12
    v_add_f32 v131, v127, v12
    v_add_f32 v8, v8, v8
    s_brev_b32 s5, 1
    s_mov_b32 s6, 0xffff
    v_cmp_gt_u32 vcc, 2, v6
    v_cos_f32 v124, v124
    v_lshrrev_b32_e64 v9, v4, s5
    v_cos_f32 v125, v125
    v_lshlrev_b32_e64 v10, v4, s6
    v_cos_f32 v126, v126
    v_alignbit_b32 v11, v9, v9, 16
    v_cos_f32 v127, v127
    v_cndmask_b32 v29, v9, 0, vcc
    v_cos_f32 v128, v128
    v_cndmask_b32 v28, -1, v10, vcc
    v_cos_f32 v129, v129
    v_cndmask_b32 v30, v9, v11, vcc
    v_cos_f32 v130, v130
    v_and_b32 v1, 28, v0
    v_cos_f32 v131, v131
    v_and_b32 v2, 24, v0
    v_lshlrev_b32 v1, 5, v1
    v_and_b32 v3, 3, v0
    v_lshl_or_b32 v1, v2, 2, v1
    v_and_b32 v2, 32, v0
    v_lshl_or_b32 v1, v3, 3, v1
    v_lshl_or_b32 v20, v2, 7, v1
    v_xor_b32 v21, 32, v20
    v_xor_b32 v22, 64, v20
    v_xor_b32 v23, 0x60, v20
    v_pk_fma_f32 v[132:133], v[8:9], v[128:129], v[124:125] op_sel_hi:[0,1,1] neg_lo:[0,0,1] neg_hi:[0,0,1]
    v_pk_fma_f32 v[134:135], v[8:9], v[130:131], v[126:127] op_sel_hi:[0,1,1] neg_lo:[0,0,1] neg_hi:[0,0,1]
    v_cvt_pk_bf16_f32 v60, v124, v125
    v_cvt_pk_bf16_f32 v61, v126, v127
    v_pk_fma_f32 v[136:137], v[8:9], v[132:133], v[128:129] op_sel_hi:[0,1,1] neg_lo:[0,0,1] neg_hi:[0,0,1]
    v_pk_fma_f32 v[138:139], v[8:9], v[134:135], v[130:131] op_sel_hi:[0,1,1] neg_lo:[0,0,1] neg_hi:[0,0,1]
    v_cvt_pk_bf16_f32 v62, v128, v129
    v_cvt_pk_bf16_f32 v63, v130, v131
    v_bitop3_b32 v76, v60, v28, v29 bitop3:0x6a
    v_bitop3_b32 v77, v61, v28, v30 bitop3:0x6a
    v_pk_fma_f32 v[140:141], v[8:9], v[136:137], v[132:133] op_sel_hi:[0,1,1] neg_lo:[0,0,1] neg_hi:[0,0,1]
    v_pk_fma_f32 v[142:143], v[8:9], v[138:139], v[134:135] op_sel_hi:[0,1,1] neg_lo:[0,0,1] neg_hi:[0,0,1]
    v_cvt_pk_bf16_f32 v64, v132, v133
    v_cvt_pk_bf16_f32 v65, v134, v135
    v_bitop3_b32 v78, v62, v28, v29 bitop3:0x6a
    v_bitop3_b32 v79, v63, v28, v30 bitop3:0x6a
    v_pk_fma_f32 v[144:145], v[8:9], v[140:141], v[136:137] op_sel_hi:[0,1,1] neg_lo:[0,0,1] neg_hi:[0,0,1]
    v_pk_fma_f32 v[146:147], v[8:9], v[142:143], v[138:139] op_sel_hi:[0,1,1] neg_lo:[0,0,1] neg_hi:[0,0,1]
    v_cvt_pk_bf16_f32 v66, v136, v137
    v_cvt_pk_bf16_f32 v67, v138, v139
    v_bitop3_b32 v80, v64, v28, v29 bitop3:0x6a
    v_bitop3_b32 v81, v65, v28, v30 bitop3:0x6a
    v_pk_fma_f32 v[148:149], v[8:9], v[144:145], v[140:141] op_sel_hi:[0,1,1] neg_lo:[0,0,1] neg_hi:[0,0,1]
    v_pk_fma_f32 v[150:151], v[8:9], v[146:147], v[142:143] op_sel_hi:[0,1,1] neg_lo:[0,0,1] neg_hi:[0,0,1]
    v_cvt_pk_bf16_f32 v68, v140, v141
    v_cvt_pk_bf16_f32 v69, v142, v143
    v_bitop3_b32 v82, v66, v28, v29 bitop3:0x6a
    v_bitop3_b32 v83, v67, v28, v30 bitop3:0x6a
    v_pk_fma_f32 v[152:153], v[8:9], v[148:149], v[144:145] op_sel_hi:[0,1,1] neg_lo:[0,0,1] neg_hi:[0,0,1]
    v_pk_fma_f32 v[154:155], v[8:9], v[150:151], v[146:147] op_sel_hi:[0,1,1] neg_lo:[0,0,1] neg_hi:[0,0,1]
    v_cvt_pk_bf16_f32 v70, v144, v145
    v_cvt_pk_bf16_f32 v71, v146, v147
    v_bitop3_b32 v84, v68, v28, v29 bitop3:0x6a
    v_bitop3_b32 v85, v69, v28, v30 bitop3:0x6a
    v_cvt_pk_bf16_f32 v72, v148, v149
    v_cvt_pk_bf16_f32 v73, v150, v151
    v_bitop3_b32 v86, v70, v28, v29 bitop3:0x6a
    v_bitop3_b32 v87, v71, v28, v30 bitop3:0x6a
    v_cvt_pk_bf16_f32 v74, v152, v153
    v_cvt_pk_bf16_f32 v75, v154, v155
    v_bitop3_b32 v88, v72, v28, v29 bitop3:0x6a
    v_bitop3_b32 v89, v73, v28, v30 bitop3:0x6a
    v_bitop3_b32 v90, v74, v28, v29 bitop3:0x6a
    v_bitop3_b32 v91, v75, v28, v30 bitop3:0x6a
    s_lshr_b32 s43, s2, 4
    s_and_b32 s5, s2, 15
    s_lshl_b32 s43, s43, 18
    s_lshl_b32 s5, s5, 8
    v_and_b32 v1, 15, v0
    s_add_u32 s43, s43, s5
    s_lshl_b32 s5, s3, 9
    v_and_b32 v2, 48, v0
    s_add_u32 s5, s5, 1048576
    v_lshlrev_b32 v1, 4, v1
    s_add_u32 s43, s43, s5
    v_lshl_or_b32 v26, v2, 8, v1
    s_mov_b32 s30, 0x10000000
    s_add_u32 s44, s43, 131072
    v_add_u32 v31, 16384, v26
    s_mov_b32 s31, 0x20000
    s_mov_b32 s42, 0x30003
    s_getreg_b32 s5, hwreg(HW_REG_XCC_ID, 0, 4)
    s_lshr_b32 s6, s2, 3
    s_lshl_b32 s5, s5, 8
    s_lshl_b32 s6, s6, 2
    s_cmp_eq_u32 s3, 192
    s_cselect_b64 s[70:71], 1, 0
    s_add_u32 s36, s5, 589824
    v_mov_b32 v39, s6
    s_waitcnt lgkmcnt(0)
    s_add_u32 s41, s40, 0x4001
    s_bitset1_b32 s41, 31
    v_mov_b32 v16, s41
    s_waitcnt vmcnt(7)
    s_barrier
    ds_read_b64_tr_b16 v[124:125], v20 offset:0
    ds_read_b64_tr_b16 v[126:127], v20 offset:8192
    ds_read_b64_tr_b16 v[128:129], v21 offset:0
    ds_read_b64_tr_b16 v[130:131], v21 offset:8192
    ds_read_b64_tr_b16 v[132:133], v22 offset:0
    ds_read_b64_tr_b16 v[134:135], v22 offset:8192
    ds_read_b64_tr_b16 v[136:137], v23 offset:0
    ds_read_b64_tr_b16 v[138:139], v23 offset:8192
    s_waitcnt lgkmcnt(6)
    v_mfma_f32_16x16x32_bf16 v[92:95], v[60:63], v[124:127], 0
    v_mfma_f32_16x16x32_bf16 v[108:111], v[76:79], v[124:127], 0
    s_waitcnt lgkmcnt(4)
    v_mfma_f32_16x16x32_bf16 v[96:99], v[60:63], v[128:131], 0
    v_mfma_f32_16x16x32_bf16 v[112:115], v[76:79], v[128:131], 0
    s_waitcnt vmcnt(6) lgkmcnt(0)
    s_barrier
    ds_read_b64_tr_b16 v[140:141], v20 offset:1024
    ds_read_b64_tr_b16 v[142:143], v20 offset:9216
    v_mfma_f32_16x16x32_bf16 v[100:103], v[60:63], v[132:135], 0
    ds_read_b64_tr_b16 v[144:145], v21 offset:1024
    ds_read_b64_tr_b16 v[146:147], v21 offset:9216
    v_mfma_f32_16x16x32_bf16 v[116:119], v[76:79], v[132:135], 0
    ds_read_b64_tr_b16 v[148:149], v22 offset:1024
    ds_read_b64_tr_b16 v[150:151], v22 offset:9216
    v_mfma_f32_16x16x32_bf16 v[104:107], v[60:63], v[136:139], 0
    ds_read_b64_tr_b16 v[152:153], v23 offset:1024
    ds_read_b64_tr_b16 v[154:155], v23 offset:9216
    v_mfma_f32_16x16x32_bf16 v[120:123], v[76:79], v[136:139], 0
    s_waitcnt lgkmcnt(6)
    v_mfma_f32_16x16x32_bf16 v[92:95], v[64:67], v[140:143], v[92:95]
    v_mfma_f32_16x16x32_bf16 v[108:111], v[80:83], v[140:143], v[108:111]
    s_waitcnt lgkmcnt(4)
    v_mfma_f32_16x16x32_bf16 v[96:99], v[64:67], v[144:147], v[96:99]
    v_mfma_f32_16x16x32_bf16 v[112:115], v[80:83], v[144:147], v[112:115]
    s_waitcnt vmcnt(5) lgkmcnt(0)
    s_barrier
    ds_read_b64_tr_b16 v[156:157], v20 offset:2048
    ds_read_b64_tr_b16 v[158:159], v20 offset:10240
    v_mfma_f32_16x16x32_bf16 v[100:103], v[64:67], v[148:151], v[100:103]
    ds_read_b64_tr_b16 v[160:161], v21 offset:2048
    ds_read_b64_tr_b16 v[162:163], v21 offset:10240
    v_mfma_f32_16x16x32_bf16 v[116:119], v[80:83], v[148:151], v[116:119]
    ds_read_b64_tr_b16 v[164:165], v22 offset:2048
    ds_read_b64_tr_b16 v[166:167], v22 offset:10240
    v_mfma_f32_16x16x32_bf16 v[104:107], v[64:67], v[152:155], v[104:107]
    ds_read_b64_tr_b16 v[168:169], v23 offset:2048
    ds_read_b64_tr_b16 v[170:171], v23 offset:10240
    v_mfma_f32_16x16x32_bf16 v[120:123], v[80:83], v[152:155], v[120:123]
    s_waitcnt lgkmcnt(6)
    v_mfma_f32_16x16x32_bf16 v[92:95], v[68:71], v[156:159], v[92:95]
    v_mfma_f32_16x16x32_bf16 v[108:111], v[84:87], v[156:159], v[108:111]
    s_waitcnt lgkmcnt(4)
    v_mfma_f32_16x16x32_bf16 v[96:99], v[68:71], v[160:163], v[96:99]
    v_mfma_f32_16x16x32_bf16 v[112:115], v[84:87], v[160:163], v[112:115]
    s_waitcnt vmcnt(4) lgkmcnt(0)
    s_barrier
    ds_read_b64_tr_b16 v[172:173], v20 offset:3072
    ds_read_b64_tr_b16 v[174:175], v20 offset:11264
    v_mfma_f32_16x16x32_bf16 v[100:103], v[68:71], v[164:167], v[100:103]
    ds_read_b64_tr_b16 v[176:177], v21 offset:3072
    ds_read_b64_tr_b16 v[178:179], v21 offset:11264
    v_mfma_f32_16x16x32_bf16 v[116:119], v[84:87], v[164:167], v[116:119]
    ds_read_b64_tr_b16 v[180:181], v22 offset:3072
    ds_read_b64_tr_b16 v[182:183], v22 offset:11264
    v_mfma_f32_16x16x32_bf16 v[104:107], v[68:71], v[168:171], v[104:107]
    ds_read_b64_tr_b16 v[184:185], v23 offset:3072
    ds_read_b64_tr_b16 v[186:187], v23 offset:11264
    v_mfma_f32_16x16x32_bf16 v[120:123], v[84:87], v[168:171], v[120:123]
    s_waitcnt lgkmcnt(6)
    v_mfma_f32_16x16x32_bf16 v[92:95], v[72:75], v[172:175], v[92:95]
    s_waitcnt lgkmcnt(4)
    v_mfma_f32_16x16x32_bf16 v[96:99], v[72:75], v[176:179], v[96:99]
    s_waitcnt lgkmcnt(2)
    v_mfma_f32_16x16x32_bf16 v[100:103], v[72:75], v[180:183], v[100:103]
    v_cvt_pk_bf16_f32 v124, v92, v93
    s_waitcnt lgkmcnt(0)
    v_mfma_f32_16x16x32_bf16 v[104:107], v[72:75], v[184:187], v[104:107]
    v_cvt_pk_bf16_f32 v128, v94, v95
    v_cvt_pk_bf16_f32 v125, v96, v97
    v_mfma_f32_16x16x32_bf16 v[108:111], v[88:91], v[172:175], v[108:111]
    v_cvt_pk_bf16_f32 v126, v100, v101
    v_bfi_b32 v124, s42, v16, v124
    v_mfma_f32_16x16x32_bf16 v[112:115], v[88:91], v[176:179], v[112:115]
    v_cvt_pk_bf16_f32 v127, v104, v105
    v_bfi_b32 v126, s42, v16, v126
    v_mfma_f32_16x16x32_bf16 v[116:119], v[88:91], v[180:183], v[116:119]
    buffer_store_dwordx4 v[124:127], v26, s[28:31], s43 offen sc1
    v_cvt_pk_bf16_f32 v129, v98, v99
    v_mfma_f32_16x16x32_bf16 v[120:123], v[88:91], v[184:187], v[120:123]
    v_cvt_pk_bf16_f32 v130, v102, v103
    v_cvt_pk_bf16_f32 v131, v106, v107
    v_bfi_b32 v128, s42, v16, v128
    v_bfi_b32 v130, s42, v16, v130
    buffer_store_dwordx4 v[128:131], v31, s[28:31], s43 offen sc1
    v_cvt_pk_bf16_f32 v132, v108, v109
    v_cvt_pk_bf16_f32 v133, v112, v113
    v_bfi_b32 v132, s42, v16, v132
    v_cvt_pk_bf16_f32 v134, v116, v117
    v_bfi_b32 v134, s42, v16, v134
    v_cvt_pk_bf16_f32 v135, v120, v121
    buffer_store_dwordx4 v[132:135], v26, s[28:31], s44 offen sc1
    v_cvt_pk_bf16_f32 v136, v110, v111
    v_cvt_pk_bf16_f32 v137, v114, v115
    v_bfi_b32 v136, s42, v16, v136
    v_cvt_pk_bf16_f32 v138, v118, v119
    v_bfi_b32 v138, s42, v16, v138
    v_cvt_pk_bf16_f32 v139, v122, v123
    buffer_store_dwordx4 v[136:139], v31, s[28:31], s44 offen sc1
    s_mov_b64 exec, s[70:71]
    buffer_store_dword v16, v39, s[28:31], s36 offen
    s_mov_b64 exec, -1
L_setup:
    s_and_b32 s62, s2, 7
    s_lshl_b32 s62, s62, 3
    s_bfe_u32 s63, s2, 0x30005
    s_add_u32 s56, s62, s63
    s_sub_u32 s62, 96, s56
    s_cmp_le_u32 s56, 32
    s_cselect_b32 s62, s56, s62
    s_lshl_b32 s62, s62, 12
    s_mul_i32 s63, s3, 12288
    s_add_u32 s65, s62, 1048576
    s_add_u32 s44, s65, s63
    v_and_b32 v1, 15, v0
    v_and_b32 v2, 48, v0
    v_lshlrev_b32 v3, 4, v1
    v_lshl_or_b32 v25, v2, 4, v3
    v_and_b32 v4, 63, v0
    v_mov_b32 v28, 0
    v_lshlrev_b32 v38, 2, v4
    s_bfe_u32 s62, s2, 0x20003
    s_lshl_b32 s62, s62, 9
    s_add_u32 s57, s56, s62
    s_movk_i32 s58, 128
    s_mov_b32 s59, -1
    s_mov_b32 s60, 0xbe800000
    s_mov_b64 s[38:39], 0
    s_cmp_lg_u32 s56, 0
    s_cbranch_scc0 L_spec
L_gen:
    s_add_u32 s45, s44, 1024
    s_add_u32 s46, s44, 2048
    s_add_u32 s47, s44, 3072
    s_add_u32 s48, s44, 262144
    s_add_u32 s49, s44, 263168
    s_add_u32 s50, s44, 264192
    s_add_u32 s51, s44, 265216
    s_add_u32 s52, s44, 524288
    s_add_u32 s53, s44, 525312
    s_add_u32 s54, s44, 526336
    s_add_u32 s55, s44, 527360
    v_bfe_u32 v1, v0, 2, 2
    v_bfe_u32 v2, v0, 4, 2
    v_and_b32 v3, 1, v0
    v_mov_b32 v4, s57
    v_mad_u32_u24 v1, v1, s58, v4
    v_cvt_f32_u32 v7, v2
    v_cvt_f32_u32 v3, v3
    v_cvt_f32_u32 v1, v1
    v_bfe_i32 v5, v0, 1, 1
    v_mul_f32 v3, 0x3e800000, v3
    v_mul_f32 v1, 0x3a000000, v1
    v_add_f32 v7, v7, v7
    v_cndmask_b32_e64 v3, v3, 0, s[38:39]
    v_cndmask_b32_e64 v1, v1, 0, s[38:39]
    v_and_b32 v6, s59, v5
    v_fma_f32 v8, v1, v7, v3
    v_xor_b32 v5, s59, v6
    v_add_f32 v10, v8, v1
    v_fmamk_f32 v12, v1, 0x41000000, v8
    v_mov_b32 v48, 0xeeee4444
    v_add_f32 v14, v12, v1
    v_add_f32 v9, s60, v8
    v_add_f32 v11, s60, v10
    v_add_f32 v13, s60, v12
    v_add_f32 v15, s60, v14
    v_cos_f32 v8, v8
    v_cos_f32 v9, v9
    v_cos_f32 v10, v10
    v_cos_f32 v11, v11
    v_cos_f32 v12, v12
    v_cos_f32 v13, v13
    v_cos_f32 v14, v14
    v_cos_f32 v15, v15
    v_mov_b64 v[108:109], 0
    v_mov_b64 v[110:111], 0
    v_mov_b64 v[112:113], 0
    v_mov_b64 v[114:115], 0
    v_mov_b64 v[116:117], 0
    v_mov_b64 v[118:119], 0
    v_mov_b64 v[120:121], 0
    v_mov_b64 v[122:123], 0
    v_mov_b64 v[124:125], 0
    v_mov_b64 v[126:127], 0
    v_mov_b64 v[128:129], 0
    v_mov_b64 v[130:131], 0
    v_cvt_pk_bf16_f32 v8, v8, v9
    v_cvt_pk_bf16_f32 v10, v10, v11
    v_cvt_pk_bf16_f32 v12, v12, v13
    v_cvt_pk_bf16_f32 v14, v14, v15
    v_and_b32 v40, v5, v8
    v_and_b32 v41, v6, v8
    v_and_b32 v42, v5, v10
    v_and_b32 v43, v6, v10
    v_and_b32 v44, v5, v12
    v_and_b32 v45, v6, v12
    v_and_b32 v46, v5, v14
    v_and_b32 v47, v6, v14
    s_lshr_b32 s62, s3, 6
    v_and_b32 v1, 15, v0
    s_mul_i32 s64, s62, s58
    v_and_b32 v5, 63, v0
    s_add_u32 s64, s64, s57
    v_mul_u32_u24 v3, 48, v1
    v_mul_u32_u24 v4, 2304, v2
    s_lshr_b32 s63, s3, 2
    s_add_u32 s63, s63, 32768
    v_lshlrev_b32 v35, 4, v5
    v_add3_u32 v24, v3, v4, s63
    v_min_u32 v4, 2, v2
    s_mul_i32 s63, s62, 2304
    v_lshlrev_b32 v4, 4, v4
    s_add_u32 s63, s63, 32768
    v_add3_u32 v27, v3, v4, s63
    v_mul_u32_u24 v3, 24, v1
    v_mul_u32_u24 v4, 6, v2
    s_mul_i32 s62, s64, 1152
    v_add_u32 v3, v3, v4
    s_sub_u32 s63, 2360442, s62
    v_and_b32 v4, 1, v2
    v_add_u32 v5, s62, v3
    v_cmp_eq_u32 vcc, 1, v4
    v_sub_u32 v6, s63, v3
    v_mov_b32 v7, 384
    v_mov_b32 v8, -384
    v_cndmask_b32 v32, v5, v6, vcc
    v_cndmask_b32 v7, v7, v8, vcc
    s_mov_b32 s22, 2359296
    s_mov_b32 s23, 0x20000
    v_add_u32 v33, v32, v7
    s_mov_b32 s26, 256
    s_mov_b32 s27, 0x20000
    v_add_u32 v34, v33, v7
    s_mov_b32 s61, 0
    s_mov_b32 s66, 0
    s_mov_b64 s[8:9], 0
    s_cmpk_ge_u32 s2, 144
    s_cbranch_scc1 L_ctag
L_join:
    s_cmp_ge_u32 s3, 192
    s_cbranch_scc1 L_w3
    s_waitcnt vmcnt(5)
    s_barrier
L_ld:
    buffer_load_dwordx4 v[60:63], v25, s[28:31], s44 offen sc1
    buffer_load_dwordx4 v[64:67], v25, s[28:31], s45 offen sc1
    buffer_load_dwordx4 v[68:71], v25, s[28:31], s46 offen sc1
    buffer_load_dwordx4 v[72:75], v25, s[28:31], s47 offen sc1
    buffer_load_dwordx4 v[76:79], v25, s[28:31], s48 offen sc1
    buffer_load_dwordx4 v[80:83], v25, s[28:31], s49 offen sc1
    buffer_load_dwordx4 v[84:87], v25, s[28:31], s50 offen sc1
    buffer_load_dwordx4 v[88:91], v25, s[28:31], s51 offen sc1
    buffer_load_dwordx4 v[92:95], v25, s[28:31], s52 offen sc1
    buffer_load_dwordx4 v[96:99], v25, s[28:31], s53 offen sc1
    buffer_load_dwordx4 v[100:103], v25, s[28:31], s54 offen sc1
    buffer_load_dwordx4 v[104:107], v25, s[28:31], s55 offen sc1
    ds_read_b128 v[188:191], v35 offset:16384
    ds_read_b128 v[196:199], v35 offset:17408
    ds_read_b128 v[200:203], v35 offset:18432
    ds_read_b128 v[204:207], v35 offset:19456
    ds_read_b128 v[208:211], v35 offset:20480
    ds_read_b128 v[212:215], v35 offset:21504
    ds_read_b128 v[216:219], v35 offset:22528
    ds_read_b128 v[220:223], v35 offset:23552
    ds_read_b128 v[224:227], v35 offset:24576
    ds_read_b128 v[228:231], v35 offset:25600
    ds_read_b128 v[232:235], v35 offset:26624
    ds_read_b128 v[236:239], v35 offset:27648
    ds_read_b128 v[240:243], v35 offset:28672
    ds_read_b128 v[244:247], v35 offset:29696
    ds_read_b128 v[248:251], v35 offset:30720
    ds_read_b128 v[252:255], v35 offset:31744
    s_waitcnt lgkmcnt(0)
    v_alignbit_b32 v192, v188, v188, 16
    v_alignbit_b32 v193, v189, v189, 16
    v_alignbit_b32 v194, v190, v190, 16
    v_alignbit_b32 v195, v191, v191, 16
    v_xor_b32 v192, 0x8000, v192
    v_xor_b32 v193, 0x8000, v193
    v_xor_b32 v194, 0x8000, v194
    v_xor_b32 v195, 0x8000, v195
    s_waitcnt vmcnt(10)
    v_smfmac_f32_16x16x64_bf16 v[108:111], v[40:43], v[60:67], v48
    v_bitop3_b32 v1, v60, v64, v16 bitop3:0x7e
    v_smfmac_f32_16x16x64_bf16 v[112:115], v[40:43], v[60:67], v48 abid:1
    v_bitop3_b32 v2, v62, v66, v16 bitop3:0x7e
    s_waitcnt vmcnt(8)
    v_smfmac_f32_16x16x64_bf16 v[108:111], v[44:47], v[68:75], v48
    v_bitop3_b32 v4, v68, v72, v16 bitop3:0x7e
    v_smfmac_f32_16x16x64_bf16 v[112:115], v[44:47], v[68:75], v48 abid:1
    v_bitop3_b32 v3, v70, v74, v16 bitop3:0x7e
    v_or3_b32 v1, v1, v2, v4
    v_or_b32 v1, v1, v3
    s_waitcnt vmcnt(6)
    v_smfmac_f32_16x16x64_bf16 v[116:119], v[40:43], v[76:83], v48
    v_bitop3_b32 v2, v76, v80, v16 bitop3:0x7e
    v_smfmac_f32_16x16x64_bf16 v[120:123], v[40:43], v[76:83], v48 abid:1
    v_bitop3_b32 v3, v78, v82, v16 bitop3:0x7e
    v_or3_b32 v1, v1, v2, v3
    v_cvt_pk_bf16_f32 v132, v108, v109
    v_cvt_pk_bf16_f32 v140, v110, v111
    v_cvt_pk_bf16_f32 v136, v112, v113
    v_cvt_pk_bf16_f32 v133, v114, v115
    s_waitcnt vmcnt(4)
    v_smfmac_f32_16x16x64_bf16 v[116:119], v[44:47], v[84:91], v48
    v_bitop3_b32 v2, v84, v88, v16 bitop3:0x7e
    v_smfmac_f32_16x16x64_bf16 v[120:123], v[44:47], v[84:91], v48 abid:1
    v_bitop3_b32 v3, v86, v90, v16 bitop3:0x7e
    v_or3_b32 v1, v1, v2, v3
    s_waitcnt vmcnt(2)
    v_smfmac_f32_16x16x64_bf16 v[124:127], v[40:43], v[92:99], v48
    v_bitop3_b32 v2, v92, v96, v16 bitop3:0x7e
    v_smfmac_f32_16x16x64_bf16 v[128:131], v[40:43], v[92:99], v48 abid:1
    v_bitop3_b32 v3, v94, v98, v16 bitop3:0x7e
    v_or3_b32 v1, v1, v2, v3
    v_cvt_pk_bf16_f32 v137, v116, v117
    v_cvt_pk_bf16_f32 v134, v118, v119
    v_cvt_pk_bf16_f32 v141, v120, v121
    v_cvt_pk_bf16_f32 v138, v122, v123
    ds_write_b96 v24, v[132:134] offset:0
    ds_write_b96 v24, v[136:138] offset:768
    ds_write_b64 v24, v[140:141] offset:1536
    s_waitcnt vmcnt(0)
    v_smfmac_f32_16x16x64_bf16 v[124:127], v[44:47], v[100:107], v48
    v_bitop3_b32 v2, v100, v104, v16 bitop3:0x7e
    v_smfmac_f32_16x16x64_bf16 v[128:131], v[44:47], v[100:107], v48 abid:1
    v_bitop3_b32 v3, v102, v106, v16 bitop3:0x7e
    v_or3_b32 v1, v1, v2, v3
    v_and_b32 v1, s42, v1
    v_cmp_ne_u32 vcc, 0, v1
    v_cvt_pk_bf16_f32 v139, v126, v127
    v_cvt_pk_bf16_f32 v142, v124, v125
    ds_write_b32 v24, v139 offset:780
    v_cvt_pk_bf16_f32 v143, v130, v131
    v_cvt_pk_bf16_f32 v135, v128, v129
    ds_write_b64 v24, v[142:143] offset:1544
    ds_write_b32 v24, v135 offset:12
    s_cbranch_vccnz L_rt
L_ok:
L_bar:
    s_waitcnt lgkmcnt(0)
    s_barrier
    ds_read_b128 v[124:127], v27 offset:0
    ds_read_b128 v[128:131], v27 offset:768
    ds_read_b128 v[132:135], v27 offset:1536
    s_cmp_eq_u32 s8, -1
    s_waitcnt lgkmcnt(2)
    v_mfma_f32_16x16x32_bf16 v[136:139], v[124:127], v[188:191], 0
    v_mfma_f32_16x16x32_bf16 v[140:143], v[124:127], v[192:195], 0
    s_waitcnt lgkmcnt(0)
    v_mfma_f32_16x16x32_bf16 v[144:147], v[128:131], v[188:191], 0
    v_mul_f32 v160, v136, v196
    v_mul_f32 v161, v137, v197
    v_mfma_f32_16x16x32_bf16 v[148:151], v[128:131], v[192:195], 0
    v_mul_f32 v162, v138, v198
    v_mul_f32 v163, v139, v199
    v_mfma_f32_16x16x32_bf16 v[152:155], v[132:135], v[188:191], 0
    v_mul_f32 v164, v136, v208
    v_mul_f32 v165, v137, v209
    v_mfma_f32_16x16x32_bf16 v[156:159], v[132:135], v[192:195], 0
    v_mul_f32 v166, v138, v210
    v_mul_f32 v167, v139, v211
    v_fmac_f32 v160, v140, v208
    v_fmac_f32 v161, v141, v209
    v_fmac_f32 v162, v142, v210
    v_fmac_f32 v163, v143, v211
    v_pk_fma_f32 v[164:165], v[140:141], v[196:197], v[164:165] neg_lo:[0,0,1] neg_hi:[0,0,1]
    v_pk_fma_f32 v[166:167], v[142:143], v[198:199], v[166:167] neg_lo:[0,0,1] neg_hi:[0,0,1]
    v_cvt_pk_bf16_f32 v176, v160, v164
    v_cvt_pk_bf16_f32 v177, v161, v165
    v_cvt_pk_bf16_f32 v178, v162, v166
    v_cvt_pk_bf16_f32 v179, v163, v167
    v_pk_mul_f32 v[168:169], v[144:145], v[200:201]
    v_pk_mul_f32 v[170:171], v[146:147], v[202:203]
    v_pk_mul_f32 v[172:173], v[144:145], v[212:213]
    v_pk_mul_f32 v[174:175], v[146:147], v[214:215]
    v_pk_fma_f32 v[168:169], v[148:149], v[212:213], v[168:169]
    v_pk_fma_f32 v[170:171], v[150:151], v[214:215], v[170:171]
    v_pk_fma_f32 v[172:173], v[148:149], v[200:201], v[172:173] neg_lo:[0,0,1] neg_hi:[0,0,1]
    v_pk_fma_f32 v[174:175], v[150:151], v[202:203], v[174:175] neg_lo:[0,0,1] neg_hi:[0,0,1]
    v_pk_mul_f32 v[84:85], v[152:153], v[204:205]
    v_pk_mul_f32 v[86:87], v[154:155], v[206:207]
    v_pk_mul_f32 v[88:89], v[152:153], v[216:217]
    v_pk_mul_f32 v[90:91], v[154:155], v[218:219]
    v_pk_fma_f32 v[84:85], v[156:157], v[216:217], v[84:85]
    v_pk_fma_f32 v[86:87], v[158:159], v[218:219], v[86:87]
    v_pk_fma_f32 v[88:89], v[156:157], v[204:205], v[88:89] neg_lo:[0,0,1] neg_hi:[0,0,1]
    v_pk_fma_f32 v[90:91], v[158:159], v[206:207], v[90:91] neg_lo:[0,0,1] neg_hi:[0,0,1]
    v_mfma_f32_16x16x32_bf16 v[60:63], v[176:179], v[220:223], 0
    v_cvt_pk_bf16_f32 v180, v168, v172
    v_cvt_pk_bf16_f32 v181, v169, v173
    v_mfma_f32_16x16x32_bf16 v[64:67], v[176:179], v[224:227], 0
    v_cvt_pk_bf16_f32 v182, v170, v174
    v_cvt_pk_bf16_f32 v183, v171, v175
    v_mfma_f32_16x16x32_bf16 v[68:71], v[176:179], v[228:231], 0
    v_cvt_pk_bf16_f32 v184, v84, v88
    v_cvt_pk_bf16_f32 v185, v85, v89
    v_mfma_f32_16x16x32_bf16 v[60:63], v[180:183], v[232:235], v[60:63]
    v_cvt_pk_bf16_f32 v186, v86, v90
    v_cvt_pk_bf16_f32 v187, v87, v91
    v_mfma_f32_16x16x32_bf16 v[64:67], v[180:183], v[236:239], v[64:67]
    v_mfma_f32_16x16x32_bf16 v[60:63], v[184:187], v[244:247], v[60:63]
    v_mfma_f32_16x16x32_bf16 v[64:67], v[184:187], v[248:251], v[64:67]
    v_mfma_f32_16x16x32_bf16 v[68:71], v[180:183], v[240:243], v[68:71]
    s_cbranch_scc1 L_sep0
    v_cvt_pk_bf16_f32 v74, v62, v61
    v_mfma_f32_16x16x32_bf16 v[68:71], v[184:187], v[252:255], v[68:71]
    v_cvt_pk_bf16_f32 v72, v60, v61
    v_cvt_pk_bf16_f32 v73, v62, v63
    v_permlane16_swap_b32 v74, v74
    v_cvt_pk_bf16_f32 v78, v66, v65
    buffer_store_dwordx3 v[72:74], v32, s[20:23], 0 offen sc1
    v_cvt_pk_bf16_f32 v76, v64, v65
    v_cvt_pk_bf16_f32 v77, v66, v67
    v_permlane16_swap_b32 v78, v78
    v_cvt_pk_bf16_f32 v82, v70, v69
    buffer_store_dwordx3 v[76:78], v33, s[20:23], 0 offen sc1
    v_cvt_pk_bf16_f32 v80, v68, v69
    v_cvt_pk_bf16_f32 v81, v70, v71
    v_permlane16_swap_b32 v82, v82
    buffer_store_dwordx3 v[80:82], v34, s[20:23], 0 offen sc1
L_eend:
    s_lshl_b32 s62, s2, 8
    s_add_u32 s62, s62, s3
    s_cmp_lg_u32 s62, 192
    s_cbranch_scc1 L_fin
    v_mov_b32 v1, 524288
    v_mov_b32 v2, s41
    s_waitcnt vmcnt(3)
    buffer_store_dword v2, v1, s[28:31], 0 offen sc1
L_fin:
L_end:
    s_endpgm
L_w3:
    s_waitcnt vmcnt(5)
    s_mov_b64 exec, 0x3ffff
L_poll:
    buffer_load_dword v28, v38, s[28:31], s36 offen sc1
    s_add_u32 s61, s61, 1
    s_waitcnt vmcnt(30)
    v_cmp_eq_u32 vcc, s41, v28
    s_bcnt1_i32_b64 s62, vcc
    s_cmp_ge_u32 s62, 14
    s_cbranch_scc1 L_pdone
    s_cmp_lt_u32 s61, 64
    s_cbranch_scc1 L_poll
L_pdone:
    s_mov_b64 exec, -1
    s_barrier
    s_cmp_lg_u32 s2, 0
    s_cbranch_scc1 L_w3b
    v_mov_b32 v1, 0
    v_mov_b32 v2, s41
    buffer_store_dword v2, v1, s[24:27], 0 offen sc1
L_w3b:
    ds_read_b128 v[188:191], v35 offset:16384
    ds_read_b128 v[196:199], v35 offset:17408
    ds_read_b128 v[200:203], v35 offset:18432
    ds_read_b128 v[204:207], v35 offset:19456
    ds_read_b128 v[208:211], v35 offset:20480
    ds_read_b128 v[212:215], v35 offset:21504
    ds_read_b128 v[216:219], v35 offset:22528
    ds_read_b128 v[220:223], v35 offset:23552
    ds_read_b128 v[224:227], v35 offset:24576
    ds_read_b128 v[228:231], v35 offset:25600
    ds_read_b128 v[232:235], v35 offset:26624
    ds_read_b128 v[236:239], v35 offset:27648
    ds_read_b128 v[240:243], v35 offset:28672
    ds_read_b128 v[244:247], v35 offset:29696
    ds_read_b128 v[248:251], v35 offset:30720
    ds_read_b128 v[252:255], v35 offset:31744
    s_waitcnt lgkmcnt(0)
    v_alignbit_b32 v192, v188, v188, 16
    v_alignbit_b32 v193, v189, v189, 16
    v_alignbit_b32 v194, v190, v190, 16
    v_alignbit_b32 v195, v191, v191, 16
    v_xor_b32 v192, 0x8000, v192
    v_xor_b32 v193, 0x8000, v193
    v_xor_b32 v194, 0x8000, v194
    v_xor_b32 v195, 0x8000, v195
    s_cmp_lg_u32 s2, 24
    s_cbranch_scc1 L_nfix
    s_mov_b32 s4, 0xff00ff00
    s_mov_b32 s5, 0xff00ff00
    s_mov_b64 exec, s[4:5]
    v_and_b32 v188, 0xffff0000, v192
    v_lshlrev_b32 v192, 16, v192
    v_and_b32 v189, 0xffff0000, v193
    v_lshlrev_b32 v193, 16, v193
    v_and_b32 v190, 0xffff0000, v194
    v_lshlrev_b32 v194, 16, v194
    v_and_b32 v191, 0xffff0000, v195
    v_lshlrev_b32 v195, 16, v195
    s_not_b64 exec, exec
    v_and_b32 v188, 0xffff, v188
    v_and_b32 v189, 0xffff, v189
    v_and_b32 v190, 0xffff, v190
    v_and_b32 v191, 0xffff, v191
    v_and_b32 v192, 0xffff, v192
    v_and_b32 v193, 0xffff, v193
    v_and_b32 v194, 0xffff, v194
    v_and_b32 v195, 0xffff, v195
    s_mov_b32 exec_lo, 0
    s_mov_b32 exec_hi, -1
    v_subrev_u32 v32, 1179648, v32
    v_subrev_u32 v33, 1179648, v33
    v_subrev_u32 v34, 1179648, v34
    s_mov_b32 exec_lo, 0xffff0000
    s_mov_b32 exec_hi, 0xffff0000
    v_swap_b32 v32, v34
    s_mov_b64 exec, -1
    s_branch L_sepi
L_sep0:
    v_mfma_f32_16x16x32_bf16 v[68:71], v[184:187], v[252:255], v[68:71]
    s_nop 2
L_sepi:
    s_nop 4
    v_cvt_pk_bf16_f32 v78, v66, v65
    v_cvt_pk_bf16_f32 v76, v64, v65
    v_cvt_pk_bf16_f32 v77, v66, v67
    v_permlane16_swap_b32 v78, v78
    v_cvt_pk_bf16_f32 v74, v62, v61
    v_cvt_pk_bf16_f32 v72, v60, v61
    v_cvt_pk_bf16_f32 v73, v62, v63
    v_permlane16_swap_b32 v74, v74
    v_cvt_pk_bf16_f32 v82, v70, v69
    v_cvt_pk_bf16_f32 v80, v68, v69
    v_cvt_pk_bf16_f32 v81, v70, v71
    v_permlane16_swap_b32 v82, v82
    s_mov_b32 exec_lo, 0xffff0000
    s_mov_b32 exec_hi, 0xffff0000
    v_swap_b32 v72, v80
    v_swap_b32 v73, v81
    v_swap_b32 v74, v82
    s_mov_b64 exec, s[8:9]
    buffer_store_dwordx3 v[76:78], v33, s[20:23], 0 offen sc1
    buffer_store_dwordx3 v[72:74], v32, s[20:23], 0 offen sc1
    buffer_store_dwordx3 v[80:82], v34, s[20:23], 0 offen sc1
    s_mov_b64 exec, -1
    s_cmp_eq_u32 s8, -1
    s_cbranch_scc1 L_eend
    s_mov_b64 s[8:9], -1
L_nfix:
    s_branch L_bar
L_cons:
    s_cmpk_ge_u32 s2, 256
    s_cbranch_scc1 L_end
    s_load_dwordx2 s[20:21], s[0:1], 40
    s_load_dwordx2 s[24:25], s[0:1], 48
    v_readfirstlane_b32 s3, v0
    s_mov_b32 s30, 0x10000000
    s_mov_b32 s31, 0x20000
    s_mov_b32 s42, 0x30003
    v_lshlrev_b32 v5, 4, v0
    s_mul_i32 s67, s3, 48
    s_lshl_b32 s62, s3, 6
    s_add_u32 s67, s67, L_tab-L_pc
    s_add_u32 m0, s62, 16384
    s_mov_b32 s34, L_tabend-L_pc
    buffer_load_dwordx4 v5, s[32:35], s67 offen lds
    buffer_load_dwordx4 v5, s[32:35], s67 offen offset:1024 lds
    buffer_load_dwordx4 v5, s[32:35], s67 offen offset:2048 lds
    buffer_load_dwordx4 v5, s[32:35], s67 offen offset:3072 lds
    s_waitcnt lgkmcnt(0)
    s_load_dword s40, s[28:29], 524288
    s_getreg_b32 s5, hwreg(HW_REG_XCC_ID, 0, 4)
    s_lshl_b32 s5, s5, 8
    v_mov_b32 v1, 0
    s_add_u32 s36, s5, 589824
    buffer_load_dword v36, v1, s[28:31], s36 offen sc1
    s_branch L_setup
L_ctag:
    s_waitcnt lgkmcnt(0)
    v_mov_b32 v1, 0
    buffer_load_dword v2, v1, s[24:27], 0 offen sc1
    s_add_u32 s41, s40, 0x4001
    s_bitset1_b32 s41, 31
    s_waitcnt vmcnt(0)
    v_readfirstlane_b32 s62, v2
    s_cmp_lg_u32 s62, 0
    s_cselect_b32 s41, s62, s41
    v_mov_b32 v16, s41
    s_branch L_join
L_spec:
    s_cmp_ge_u32 s62, 1024
    s_cbranch_scc1 L_typa
    s_add_u32 s57, s57, 64
    s_mov_b32 s59, 0xffff0000
    s_mov_b32 s60, 0
    s_branch L_gen
L_typa:
    s_sub_u32 s57, s57, 896
    s_mov_b32 s59, 0xffff
    s_cmp_eq_u32 s2, 24
    s_cselect_b32 s38, 0xa000a000, 0
    s_mov_b32 s39, s38
    s_branch L_gen
L_rt:
    s_add_u32 s66, s66, 1
    s_cmp_ge_u32 s66, 20000
    s_cbranch_scc1 L_ok
    s_waitcnt lgkmcnt(0)
    v_mov_b64 v[108:109], 0
    v_mov_b64 v[110:111], 0
    v_mov_b64 v[112:113], 0
    v_mov_b64 v[114:115], 0
    v_mov_b64 v[116:117], 0
    v_mov_b64 v[118:119], 0
    v_mov_b64 v[120:121], 0
    v_mov_b64 v[122:123], 0
    v_mov_b64 v[124:125], 0
    v_mov_b64 v[126:127], 0
    v_mov_b64 v[128:129], 0
    v_mov_b64 v[130:131], 0
    s_branch L_ld
.p2align 7
.type L_tab,@object
L_tab:
.long 0x00003f80, 0x00003f80, 0x00003f80, 0x00003f80, 0x00003f80, 0x3f003f5e, 0x3f5e3f00, 0x3f800000
.long 0x00003f80, 0x3f5e3f00, 0x3f5ebf00, 0x0000bf80, 0x00003f80, 0x3f800000, 0x0000bf80, 0xbf800000
.long 0x00003f80, 0x0000bf80, 0x00003f80, 0x0000bf80, 0x00003f80, 0x3f00bf5e, 0xbf5e3f00, 0x3f800000
.long 0x00003f80, 0x3f5ebf00, 0xbf5ebf00, 0x00003f80, 0x00003f80, 0x3f800000, 0x0000bf80, 0xbf800000
.long 0x00003f80, 0x0000bf80, 0x00003f80, 0x0000bf80, 0x00003f80, 0xbf00bf5e, 0x3f5e3f00, 0xbf800000
.long 0x00003f80, 0xbf5ebf00, 0x3f5ebf00, 0x00003f80, 0x00003f80, 0xbf800000, 0x0000bf80, 0x3f800000
.long 0x00003f80, 0x00003f80, 0x00003f80, 0x00003f80, 0x00003f80, 0xbf003f5e, 0xbf5e3f00, 0xbf800000
.long 0x00003f80, 0xbf5e3f00, 0xbf5ebf00, 0x0000bf80, 0x00003f80, 0xbf800000, 0x0000bf80, 0x3f800000
.long 0x00003f80, 0x00003f80, 0x00003f80, 0x00003f80, 0x3f5ebf00, 0x3f00bf5e, 0x0000bf80, 0xbf00bf5e
.long 0xbf5ebf00, 0xbf5e3f00, 0x00003f80, 0x3f5e3f00, 0x00003f80, 0x3f800000, 0x0000bf80, 0xbf800000
.long 0x00003f80, 0x0000bf80, 0x00003f80, 0x0000bf80, 0xbf5ebf00, 0x3f003f5e, 0x0000bf80, 0xbf003f5e
.long 0x3f5ebf00, 0xbf5ebf00, 0x00003f80, 0x3f5ebf00, 0x00003f80, 0x3f800000, 0x0000bf80, 0xbf800000
.long 0x00003f80, 0x0000bf80, 0x00003f80, 0x0000bf80, 0x3f5ebf00, 0xbf003f5e, 0x0000bf80, 0x3f003f5e
.long 0xbf5ebf00, 0x3f5ebf00, 0x00003f80, 0xbf5ebf00, 0x00003f80, 0xbf800000, 0x0000bf80, 0x3f800000
.long 0x00003f80, 0x00003f80, 0x00003f80, 0x00003f80, 0xbf5ebf00, 0xbf00bf5e, 0x0000bf80, 0x3f00bf5e
.long 0x3f5ebf00, 0x3f5e3f00, 0x00003f80, 0xbf5e3f00, 0x00003f80, 0xbf800000, 0x0000bf80, 0x3f800000
.long 0x00003f80, 0x00003f80, 0x00003f80, 0x00003f80, 0xbf5ebf00, 0xbf800000, 0xbf5e3f00, 0xbf003f5e
.long 0x3f5ebf00, 0x0000bf80, 0xbf5ebf00, 0xbf5e3f00, 0x00003f80, 0x3f800000, 0x0000bf80, 0xbf800000
.long 0x00003f80, 0x0000bf80, 0x00003f80, 0x0000bf80, 0x3f5ebf00, 0xbf800000, 0x3f5e3f00, 0xbf00bf5e
.long 0xbf5ebf00, 0x00003f80, 0x3f5ebf00, 0xbf5ebf00, 0x00003f80, 0x3f800000, 0x0000bf80, 0xbf800000
.long 0x00003f80, 0x0000bf80, 0x00003f80, 0x0000bf80, 0xbf5ebf00, 0x3f800000, 0xbf5e3f00, 0x3f00bf5e
.long 0x3f5ebf00, 0x00003f80, 0xbf5ebf00, 0x3f5ebf00, 0x00003f80, 0xbf800000, 0x0000bf80, 0x3f800000
.long 0x00003f80, 0x00003f80, 0x00003f80, 0x00003f80, 0x3f5ebf00, 0x3f800000, 0x3f5e3f00, 0x3f003f5e
.long 0xbf5ebf00, 0x0000bf80, 0x3f5ebf00, 0x3f5e3f00, 0x00003f80, 0xbf800000, 0x0000bf80, 0x3f800000
.long 0x00000000, 0x00000000, 0x00000000, 0x00000000, 0x00000000, 0x00000000, 0x00000000, 0x00000000
.long 0x00000000, 0x00000000, 0x00000000, 0x00000000, 0x00000000, 0x00000000, 0x00000000, 0x00000000
.long 0x00000000, 0x00000000, 0x00000000, 0x00000000, 0x00000000, 0x00000000, 0x00000000, 0x00000000
.long 0x00000000, 0x00000000, 0x00000000, 0x00000000, 0x00000000, 0x00000000, 0x00000000, 0x00000000
.long 0x00000000, 0x00000000, 0x00000000, 0x00000000, 0x00000000, 0x00000000, 0x00000000, 0x00000000
.long 0x00000000, 0x00000000, 0x00000000, 0x00000000, 0x00000000, 0x00000000, 0x00000000, 0x00000000
.long 0x00000000, 0x00000000, 0x00000000, 0x00000000, 0x00000000, 0x00000000, 0x00000000, 0x00000000
.long 0x00000000, 0x00000000, 0x00000000, 0x00000000, 0x00000000, 0x00000000, 0x00000000, 0x00000000
.long 0x3f800000, 0x3f800000, 0x3f800000, 0x3f800000, 0x3f800000, 0x3f7ffc1a, 0x3f7ff067, 0x3f7fdce9
.long 0x3f800000, 0x3f7ff067, 0x3f7fc1a0, 0x3f7f73af, 0x3f800000, 0x3f7fdce9, 0x3f7f73af, 0x3f7ec46d
.long 0x3f800000, 0x3f7f73af, 0x3f7dcf55, 0x3f7b14be, 0x3f800000, 0x3f7f9e8c, 0x3f7e7a7a, 0x3f7c94a8
.long 0x3f800000, 0x3f7fc1a0, 0x3f7f069e, 0x3f7dcf55, 0x3f800000, 0x3f7fdce9, 0x3f7f73af, 0x3f7ec46d
.long 0x3f800000, 0x3f7f73af, 0x3f7dcf55, 0x3f7b14be, 0x3f800000, 0x3f7f4109, 0x3f7d0543, 0x3f795000
.long 0x3f800000, 0x3f7f069e, 0x3f7c1c5c, 0x3f7746ea, 0x3f800000, 0x3f7ec46d, 0x3f7b14be, 0x3f74fa0b
.long 0x3f800000, 0x3f7dcf55, 0x3f7746ea, 0x3f6c835e, 0x3f800000, 0x3f7e28c6, 0x3f78a9e0, 0x3f6f9788
.long 0x3f800000, 0x3f7e7a7a, 0x3f79ee89, 0x3f726a03, 0x3f800000, 0x3f7ec46d, 0x3f7b14be, 0x3f74fa0b
.long 0x3f800000, 0x3f800000, 0x3f800000, 0x3f800000, 0x3f7fc1a0, 0x3f7f9e8c, 0x3f7f73af, 0x3f7f4109
.long 0x3f7f069e, 0x3f7e7a7a, 0x3f7dcf55, 0x3f7d0543, 0x3f7dcf55, 0x3f7c94a8, 0x3f7b14be, 0x3f795000
.long 0x3f7746ea, 0x3f726a03, 0x3f6c835e, 0x3f659974, 0x3f79ee89, 0x3f768a20, 0x3f726a03, 0x3f6d9156
.long 0x3f7c1c5c, 0x3f79ee89, 0x3f7746ea, 0x3f7426cb, 0x3f7dcf55, 0x3f7c94a8, 0x3f7b14be, 0x3f795000
.long 0x3f7746ea, 0x3f726a03, 0x3f6c835e, 0x3f659974, 0x3f7426cb, 0x3f6d9156, 0x3f659974, 0x3f5c4b07
.long 0x3f708fb2, 0x3f6803ca, 0x3f5db3d7, 0x3f51b3f3, 0x3f6c835e, 0x3f61c598, 0x3f54db31, 0x3f45e403
.long 0x3f5db3d7, 0x3f4b1934, 0x3f3504f3, 0x3f1bd7ca, 0x3f631324, 0x3f534aca, 0x3f407893, 0x3f2ae1c9
.long 0x3f6803ca, 0x3f5adb81, 0x3f4b1934, 0x3f38ecd8, 0x3f6c835e, 0x3f61c598, 0x3f54db31, 0x3f45e403
.long 0x3f800000, 0x3f800000, 0x3f800000, 0x3f800000, 0x3f7f069e, 0x3f7ec46d, 0x3f7e7a7a, 0x3f7e28c6
.long 0x3f7c1c5c, 0x3f7b14be, 0x3f79ee89, 0x3f78a9e0, 0x3f7746ea, 0x3f74fa0b, 0x3f726a03, 0x3f6f9788
.long 0x3f5db3d7, 0x3f54db31, 0x3f4b1934, 0x3f407893, 0x3f6803ca, 0x3f61c598, 0x3f5adb81, 0x3f534aca
.long 0x3f708fb2, 0x3f6c835e, 0x3f6803ca, 0x3f631324, 0x3f7746ea, 0x3f74fa0b, 0x3f726a03, 0x3f6f9788
.long 0x3f5db3d7, 0x3f54db31, 0x3f4b1934, 0x3f407893, 0x3f51b3f3, 0x3f45e403, 0x3f38ecd8, 0x3f2ae1c9
.long 0x3f441b7d, 0x3f3504f3, 0x3f248dbb, 0x3f12d5e8, 0x3f3504f3, 0x3f226799, 0x3f0e39da, 0x3ef15aea
.long 0x3f000000, 0x3ec3ef15, 0x3e8483ee, 0x3e05a8a8, 0x3f12d5e8, 0x3ef15aea, 0x3eb9917b, 0x3e7e39c4
.long 0x3f248dbb, 0x3f0e39da, 0x3eec6a50, 0x3eb9917b, 0x3f3504f3, 0x3f226799, 0x3f0e39da, 0x3ef15aea
.long 0x3f800000, 0x3f800000, 0x3f800000, 0x3f800000, 0x3f7dcf55, 0x3f7d6e28, 0x3f7d0543, 0x3f7c94a8
.long 0x3f7746ea, 0x3f75c5d4, 0x3f7426cb, 0x3f726a03, 0x3f6c835e, 0x3f692e5f, 0x3f659974, 0x3f61c598
.long 0x3f3504f3, 0x3f28cae3, 0x3f1bd7ca, 0x3f0e39da, 0x3f4b1934, 0x3f424cfe, 0x3f38ecd8, 0x3f2effe8
.long 0x3f5db3d7, 0x3f57e880, 0x3f51b3f3, 0x3f4b1934, 0x3f6c835e, 0x3f692e5f, 0x3f659974, 0x3f61c598
.long 0x3f3504f3, 0x3f28cae3, 0x3f1bd7ca, 0x3f0e39da, 0x3f1bd7ca, 0x3f0be54a, 0x3ef64429, 0x3ed34e56
.long 0x3f000000, 0x3ed8616c, 0x3eaf1d44, 0x3e8483ee, 0x3ec3ef15, 0x3e94a031, 0x3e47c5c2, 0x3dc8bd36
.long 0x00000000, 0xbe05a8a8, 0xbe8483ee, 0xbec3ef15, 0x3e05a8a8, 0x3c32b7da, 0xbddef599, 0xbe6886ae
.long 0x3e8483ee, 0x3e1bc63c, 0x3d32aa3e, 0xbd85f213, 0x3ec3ef15, 0x3e94a031, 0x3e47c5c2, 0x3dc8bd36
.long 0x3f800000, 0x3f800000, 0x3f800000, 0x3f800000, 0x3f7c1c5c, 0x3f7b9c62, 0x3f7b14be, 0x3f7a8575
.long 0x3f708fb2, 0x3f6e9811, 0x3f6c835e, 0x3f6a51da, 0x3f5db3d7, 0x3f596550, 0x3f54db31, 0x3f5016b8
.long 0x3f000000, 0x3ee273aa, 0x3ec3ef15, 0x3ea493b7, 0x3f248dbb, 0x3f199e45, 0x3f0e39da, 0x3f026926
.long 0x3f441b7d, 0x3f3cbe35, 0x3f3504f3, 0x3f2cf37b, 0x3f5db3d7, 0x3f596550, 0x3f54db31, 0x3f5016b8
.long 0x3f000000, 0x3ee273aa, 0x3ec3ef15, 0x3ea493b7, 0x3eaf1d44, 0x3e89e6f1, 0x3e47c5c2, 0x3df52731
.long 0x3e31d0d4, 0x3db27eb6, 0x00000000, 0xbdb27eb6, 0x00000000, 0xbdc8bd36, 0xbe47c5c2, 0xbe94a031
.long 0xbf000000, 0xbf1bd7ca, 0xbf3504f3, 0xbf4b1934, 0xbeaf1d44, 0xbee77284, 0xbf0e39da, 0xbf26aed9
.long 0xbe31d0d4, 0xbe8f45c0, 0xbec3ef15, 0xbef64429, 0x00000000, 0xbdc8bd36, 0xbe47c5c2, 0xbe94a031
.long 0x3f800000, 0x3f800000, 0x3f800000, 0x3f800000, 0x3f79ee89, 0x3f795000, 0x3f78a9e0, 0x3f77fc2c
.long 0x3f6803ca, 0x3f659974, 0x3f631324, 0x3f60712a, 0x3f4b1934, 0x3f45e403, 0x3f407893, 0x3f3ad85f
.long 0x3e8483ee, 0x3e47c5c2, 0x3e05a8a8, 0x3d85f213, 0x3eec6a50, 0x3ed34e56, 0x3eb9917b, 0x3e9f4757
.long 0x3f248dbb, 0x3f1bd7ca, 0x3f12d5e8, 0x3f098c78, 0x3f4b1934, 0x3f45e403, 0x3f407893, 0x3f3ad85f
.long 0x3e8483ee, 0x3e47c5c2, 0x3e05a8a8, 0x3d85f213, 0x3d32aa3e, 0xbd060472, 0xbddef599, 0xbe3cce2b
.long 0xbe31d0d4, 0xbe8483ee, 0xbeaf1d44, 0xbed8616c, 0xbec3ef15, 0xbef15aea, 0xbf0e39da, 0xbf226799
.long 0xbf5db3d7, 0xbf6c835e, 0xbf7746ea, 0xbf7dcf55, 0xbf3cbe35, 0xbf5016b8, 0xbf60712a, 0xbf6d9156
.long 0xbf12d5e8, 0xbf28cae3, 0xbf3cbe35, 0xbf4e7327, 0xbec3ef15, 0xbef15aea, 0xbf0e39da, 0xbf226799
.long 0x3f800000, 0x3f800000, 0x3f800000, 0x3f800000, 0x3f7746ea, 0x3f768a20, 0x3f75c5d4, 0x3f74fa0b
.long 0x3f5db3d7, 0x3f5adb81, 0x3f57e880, 0x3f54db31, 0x3f3504f3, 0x3f2effe8, 0x3f28cae3, 0x3f226799
.long 0x00000000, 0xbd85f213, 0xbe05a8a8, 0xbe47c5c2, 0x3e8483ee, 0x3e52b743, 0x3e1bc63c, 0x3dc8bd36
.long 0x3f000000, 0x3eec6a50, 0x3ed8616c, 0x3ec3ef15, 0x3f3504f3, 0x3f2effe8, 0x3f28cae3, 0x3f226799
.long 0x00000000, 0xbd85f213, 0xbe05a8a8, 0xbe47c5c2, 0xbe8483ee, 0xbea9db13, 0xbece34d0, 0xbef15aea
.long 0xbf000000, 0xbf12d5e8, 0xbf248dbb, 0xbf3504f3, 0xbf3504f3, 0xbf45e403, 0xbf54db31, 0xbf61c598
.long 0xbf800000, 0xbf7dcf55, 0xbf7746ea, 0xbf6c835e, 0xbf7746ea, 0xbf7d6e28, 0xbf7ff067, 0xbf7ec46d
.long 0xbf5db3d7, 0xbf6a51da, 0xbf7426cb, 0xbf7b14be, 0xbf3504f3, 0xbf45e403, 0xbf54db31, 0xbf61c598
.long 0x3f800000, 0x3f800000, 0x3f800000, 0x3f800000, 0x3f7426cb, 0x3f734c1c, 0x3f726a03, 0x3f718088
.long 0x3f51b3f3, 0x3f4e7327, 0x3f4b1934, 0x3f47a682, 0x3f1bd7ca, 0x3f151d42, 0x3f0e39da, 0x3f072f74
.long 0xbe8483ee, 0xbea493b7, 0xbec3ef15, 0xbee273aa, 0x3d32aa3e, 0xbc32b7da, 0xbd85f213, 0xbdf52731
.long 0x3eaf1d44, 0x3e99f61c, 0x3e8483ee, 0x3e5da259, 0x3f1bd7ca, 0x3f151d42, 0x3f0e39da, 0x3f072f74
.long 0xbe8483ee, 0xbea493b7, 0xbec3ef15, 0xbee273aa, 0xbf098c78, 0xbf199e45, 0xbf28cae3, 0xbf36fbaf
.long 0xbf441b7d, 0xbf51b3f3, 0xbf5db3d7, 0xbf6803ca, 0xbf6c835e, 0xbf74fa0b, 0xbf7b14be, 0xbf7ec46d
.long 0xbf5db3d7, 0xbf4b1934, 0xbf3504f3, 0xbf1bd7ca, 0xbf79ee89, 0xbf718088, 0xbf659974, 0xbf56651d
.long 0xbf7f069e, 0xbf7ff067, 0xbf7dcf55, 0xbf78a9e0, 0xbf6c835e, 0xbf74fa0b, 0xbf7b14be, 0xbf7ec46d
.long 0x3f800000, 0x3f800000, 0x3f800000, 0x3f800000, 0x3f708fb2, 0x3f6f9788, 0x3f6e9811, 0x3f6d9156
.long 0x3f441b7d, 0x3f407893, 0x3f3cbe35, 0x3f38ecd8, 0x3f000000, 0x3ef15aea, 0x3ee273aa, 0x3ed34e56
.long 0xbf000000, 0xbf0e39da, 0xbf1bd7ca, 0xbf28cae3, 0xbe31d0d4, 0xbe6886ae, 0xbe8f45c0, 0xbea9db13
.long 0x3e31d0d4, 0x3e05a8a8, 0x3db27eb6, 0x3d32aa3e, 0x3f000000, 0x3ef15aea, 0x3ee273aa, 0x3ed34e56
.long 0xbf000000, 0xbf0e39da, 0xbf1bd7ca, 0xbf28cae3, 0xbf441b7d, 0xbf5016b8, 0xbf5adb81, 0xbf6459c6
.long 0xbf708fb2, 0xbf7746ea, 0xbf7c1c5c, 0xbf7f069e, 0xbf800000, 0xbf7ec46d, 0xbf7b14be, 0xbf74fa0b
.long 0xbf000000, 0xbec3ef15, 0xbe8483ee, 0xbe05a8a8, 0xbf441b7d, 0xbf2effe8, 0xbf176012, 0xbefb25e8
.long 0xbf708fb2, 0xbf659974, 0xbf57e880, 0xbf47a682, 0xbf800000, 0xbf7ec46d, 0xbf7b14be, 0xbf74fa0b
.long 0x3f800000, 0x3f800000, 0x3f800000, 0x3f800000, 0x3f6c835e, 0x3f6b6e32, 0x3f6a51da, 0x3f692e5f
.long 0x3f3504f3, 0x3f310700, 0x3f2cf37b, 0x3f28cae3, 0x3ec3ef15, 0x3eb45a1e, 0x3ea493b7, 0x3e94a031
.long 0xbf3504f3, 0xbf407893, 0xbf4b1934, 0xbf54db31, 0xbec3ef15, 0xbedd6dea, 0xbef64429, 0xbf072f74
.long 0x00000000, 0xbd32aa3e, 0xbdb27eb6, 0xbe05a8a8, 0x3ec3ef15, 0x3eb45a1e, 0x3ea493b7, 0x3e94a031
.long 0xbf3504f3, 0xbf407893, 0xbf4b1934, 0xbf54db31, 0xbf6c835e, 0xbf734c1c, 0xbf78a9e0, 0xbf7c94a8
.long 0xbf800000, 0xbf7f069e, 0xbf7c1c5c, 0xbf7746ea, 0xbf6c835e, 0xbf61c598, 0xbf54db31, 0xbf45e403
.long 0x00000000, 0x3e05a8a8, 0x3e8483ee, 0x3ec3ef15, 0xbec3ef15, 0xbe89e6f1, 0xbe1bc63c, 0xbd060472
.long 0xbf3504f3, 0xbf203c85, 0xbf098c78, 0xbee273aa, 0xbf6c835e, 0xbf61c598, 0xbf54db31, 0xbf45e403
.long 0x3f800000, 0x3f800000, 0x3f800000, 0x3f800000, 0x3f6803ca, 0x3f66d223, 0x3f659974, 0x3f6459c6
.long 0x3f248dbb, 0x3f203c85, 0x3f1bd7ca, 0x3f176012, 0x3e8483ee, 0x3e6886ae, 0x3e47c5c2, 0x3e26ce12
.long 0xbf5db3d7, 0xbf659974, 0xbf6c835e, 0xbf726a03, 0xbf12d5e8, 0xbf1e0c90, 0xbf28cae3, 0xbf3308b4
.long 0xbe31d0d4, 0xbe5da259, 0xbe8483ee, 0xbe99f61c, 0x3e8483ee, 0x3e6886ae, 0x3e47c5c2, 0x3e26ce12
.long 0xbf5db3d7, 0xbf659974, 0xbf6c835e, 0xbf726a03, 0xbf7f069e, 0xbf7ffc1a, 0xbf7f73af, 0xbf7d6e28
.long 0xbf708fb2, 0xbf6803ca, 0xbf5db3d7, 0xbf51b3f3, 0xbf3504f3, 0xbf226799, 0xbf0e39da, 0xbef15aea
.long 0x3f000000, 0x3f1bd7ca, 0x3f3504f3, 0x3f4b1934, 0x3db27eb6, 0x3e52b743, 0x3ea493b7, 0x3edd6dea
.long 0xbeaf1d44, 0xbe7363ee, 0xbe05a8a8, 0xbcb2b521, 0xbf3504f3, 0xbf226799, 0xbf0e39da, 0xbef15aea
.long 0x3f800000, 0x3f800000, 0x3f800000, 0x3f800000, 0x3f631324, 0x3f61c598, 0x3f60712a, 0x3f5f15e7
.long 0x3f12d5e8, 0x3f0e39da, 0x3f098c78, 0x3f04ce53, 0x3e05a8a8, 0x3dc8bd36, 0x3d85f213, 0x3d060472
.long 0xbf7746ea, 0xbf7b14be, 0xbf7dcf55, 0xbf7f73af, 0xbf3cbe35, 0xbf45e403, 0xbf4e7327, 0xbf56651d
.long 0xbeaf1d44, 0xbec3ef15, 0xbed8616c, 0xbeec6a50, 0x3e05a8a8, 0x3dc8bd36, 0x3d85f213, 0x3d060472
.long 0xbf7746ea, 0xbf7b14be, 0xbf7dcf55, 0xbf7f73af, 0xbf79ee89, 0xbf74fa0b, 0xbf6e9811, 0xbf66d223
.long 0xbf441b7d, 0xbf3504f3, 0xbf248dbb, 0xbf12d5e8, 0xbec3ef15, 0xbe94a031, 0xbe47c5c2, 0xbdc8bd36
.long 0x3f5db3d7, 0x3f6c835e, 0x3f7746ea, 0x3f7dcf55, 0x3f098c78, 0x3f226799, 0x3f38ecd8, 0x3f4cc94c
.long 0x3db27eb6, 0x3e47c5c2, 0x3e99f61c, 0x3ece34d0, 0xbec3ef15, 0xbe94a031, 0xbe47c5c2, 0xbdc8bd36
.long 0x00000000, 0x00000000, 0x00000000, 0x00000000, 0x00000000, 0x3c32b7da, 0x3cb2b521, 0x3d060472
.long 0x00000000, 0x3cb2b521, 0x3d32aa3e, 0x3d85f213, 0x00000000, 0x3d060472, 0x3d85f213, 0x3dc8bd36
.long 0x00000000, 0x3d85f213, 0x3e05a8a8, 0x3e47c5c2, 0x00000000, 0x3d5f4a99, 0x3ddef599, 0x3e26ce12
.long 0x00000000, 0x3d32aa3e, 0x3db27eb6, 0x3e05a8a8, 0x00000000, 0x3d060472, 0x3d85f213, 0x3dc8bd36
.long 0x00000000, 0x3d85f213, 0x3e05a8a8, 0x3e47c5c2, 0x00000000, 0x3d9c3ac6, 0x3e1bc63c, 0x3e6886ae
.long 0x00000000, 0x3db27eb6, 0x3e31d0d4, 0x3e8483ee, 0x00000000, 0x3dc8bd36, 0x3e47c5c2, 0x3e94a031
.long 0x00000000, 0x3e05a8a8, 0x3e8483ee, 0x3ec3ef15, 0x00000000, 0x3df52731, 0x3e7363ee, 0x3eb45a1e
.long 0x00000000, 0x3ddef599, 0x3e5da259, 0x3ea493b7, 0x00000000, 0x3dc8bd36, 0x3e47c5c2, 0x3e94a031
.long 0x00000000, 0x00000000, 0x00000000, 0x00000000, 0x3d32aa3e, 0x3d5f4a99, 0x3d85f213, 0x3d9c3ac6
.long 0x3db27eb6, 0x3ddef599, 0x3e05a8a8, 0x3e1bc63c, 0x3e05a8a8, 0x3e26ce12, 0x3e47c5c2, 0x3e6886ae
.long 0x3e8483ee, 0x3ea493b7, 0x3ec3ef15, 0x3ee273aa, 0x3e5da259, 0x3e89e6f1, 0x3ea493b7, 0x3ebec330
.long 0x3e31d0d4, 0x3e5da259, 0x3e8483ee, 0x3e99f61c, 0x3e05a8a8, 0x3e26ce12, 0x3e47c5c2, 0x3e6886ae
.long 0x3e8483ee, 0x3ea493b7, 0x3ec3ef15, 0x3ee273aa, 0x3e99f61c, 0x3ebec330, 0x3ee273aa, 0x3f026926
.long 0x3eaf1d44, 0x3ed8616c, 0x3f000000, 0x3f12d5e8, 0x3ec3ef15, 0x3ef15aea, 0x3f0e39da, 0x3f226799
.long 0x3f000000, 0x3f1bd7ca, 0x3f3504f3, 0x3f4b1934, 0x3eec6a50, 0x3f108a14, 0x3f28cae3, 0x3f3e9e4b
.long 0x3ed8616c, 0x3f04ce53, 0x3f1bd7ca, 0x3f310700, 0x3ec3ef15, 0x3ef15aea, 0x3f0e39da, 0x3f226799
.long 0x00000000, 0x00000000, 0x00000000, 0x00000000, 0x3db27eb6, 0x3dc8bd36, 0x3ddef599, 0x3df52731
.long 0x3e31d0d4, 0x3e47c5c2, 0x3e5da259, 0x3e7363ee, 0x3e8483ee, 0x3e94a031, 0x3ea493b7, 0x3eb45a1e
.long 0x3f000000, 0x3f0e39da, 0x3f1bd7ca, 0x3f28cae3, 0x3ed8616c, 0x3ef15aea, 0x3f04ce53, 0x3f108a14
.long 0x3eaf1d44, 0x3ec3ef15, 0x3ed8616c, 0x3eec6a50, 0x3e8483ee, 0x3e94a031, 0x3ea493b7, 0x3eb45a1e
.long 0x3f000000, 0x3f0e39da, 0x3f1bd7ca, 0x3f28cae3, 0x3f12d5e8, 0x3f226799, 0x3f310700, 0x3f3e9e4b
.long 0x3f248dbb, 0x3f3504f3, 0x3f441b7d, 0x3f51b3f3, 0x3f3504f3, 0x3f45e403, 0x3f54db31, 0x3f61c598
.long 0x3f5db3d7, 0x3f6c835e, 0x3f7746ea, 0x3f7dcf55, 0x3f51b3f3, 0x3f61c598, 0x3f6e9811, 0x3f77fc2c
.long 0x3f441b7d, 0x3f54db31, 0x3f631324, 0x3f6e9811, 0x3f3504f3, 0x3f45e403, 0x3f54db31, 0x3f61c598
.long 0x00000000, 0x00000000, 0x00000000, 0x00000000, 0x3e05a8a8, 0x3e10b9a6, 0x3e1bc63c, 0x3e26ce12
.long 0x3e8483ee, 0x3e8f45c0, 0x3e99f61c, 0x3ea493b7, 0x3ec3ef15, 0x3ed34e56, 0x3ee273aa, 0x3ef15aea
.long 0x3f3504f3, 0x3f407893, 0x3f4b1934, 0x3f54db31, 0x3f1bd7ca, 0x3f26aed9, 0x3f310700, 0x3f3ad85f
.long 0x3f000000, 0x3f098c78, 0x3f12d5e8, 0x3f1bd7ca, 0x3ec3ef15, 0x3ed34e56, 0x3ee273aa, 0x3ef15aea
.long 0x3f3504f3, 0x3f407893, 0x3f4b1934, 0x3f54db31, 0x3f4b1934, 0x3f56651d, 0x3f60712a, 0x3f692e5f
.long 0x3f5db3d7, 0x3f6803ca, 0x3f708fb2, 0x3f7746ea, 0x3f6c835e, 0x3f74fa0b, 0x3f7b14be, 0x3f7ec46d
.long 0x3f800000, 0x3f7dcf55, 0x3f7746ea, 0x3f6c835e, 0x3f7dcf55, 0x3f7ffc1a, 0x3f7e7a7a, 0x3f795000
.long 0x3f7746ea, 0x3f7d0543, 0x3f7fc1a0, 0x3f7f73af, 0x3f6c835e, 0x3f74fa0b, 0x3f7b14be, 0x3f7ec46d
.long 0x00000000, 0x00000000, 0x00000000, 0x00000000, 0x3e31d0d4, 0x3e3cce2b, 0x3e47c5c2, 0x3e52b743
.long 0x3eaf1d44, 0x3eb9917b, 0x3ec3ef15, 0x3ece34d0, 0x3f000000, 0x3f072f74, 0x3f0e39da, 0x3f151d42
.long 0x3f5db3d7, 0x3f659974, 0x3f6c835e, 0x3f726a03, 0x3f441b7d, 0x3f4cc94c, 0x3f54db31, 0x3f5c4b07
.long 0x3f248dbb, 0x3f2cf37b, 0x3f3504f3, 0x3f3cbe35, 0x3f000000, 0x3f072f74, 0x3f0e39da, 0x3f151d42
.long 0x3f5db3d7, 0x3f659974, 0x3f6c835e, 0x3f726a03, 0x3f708fb2, 0x3f768a20, 0x3f7b14be, 0x3f7e28c6
.long 0x3f7c1c5c, 0x3f7f069e, 0x3f800000, 0x3f7f069e, 0x3f800000, 0x3f7ec46d, 0x3f7b14be, 0x3f74fa0b
.long 0x3f5db3d7, 0x3f4b1934, 0x3f3504f3, 0x3f1bd7ca, 0x3f708fb2, 0x3f6459c6, 0x3f54db31, 0x3f424cfe
.long 0x3f7c1c5c, 0x3f75c5d4, 0x3f6c835e, 0x3f60712a, 0x3f800000, 0x3f7ec46d, 0x3f7b14be, 0x3f74fa0b
.long 0x00000000, 0x00000000, 0x00000000, 0x00000000, 0x3e5da259, 0x3e6886ae, 0x3e7363ee, 0x3e7e39c4
.long 0x3ed8616c, 0x3ee273aa, 0x3eec6a50, 0x3ef64429, 0x3f1bd7ca, 0x3f226799, 0x3f28cae3, 0x3f2effe8
.long 0x3f7746ea, 0x3f7b14be, 0x3f7dcf55, 0x3f7f73af, 0x3f631324, 0x3f692e5f, 0x3f6e9811, 0x3f734c1c
.long 0x3f441b7d, 0x3f4b1934, 0x3f51b3f3, 0x3f57e880, 0x3f1bd7ca, 0x3f226799, 0x3f28cae3, 0x3f2effe8
.long 0x3f7746ea, 0x3f7b14be, 0x3f7dcf55, 0x3f7f73af, 0x3f7fc1a0, 0x3f7fdce9, 0x3f7e7a7a, 0x3f7b9c62
.long 0x3f7c1c5c, 0x3f7746ea, 0x3f708fb2, 0x3f6803ca, 0x3f6c835e, 0x3f61c598, 0x3f54db31, 0x3f45e403
.long 0x3f000000, 0x3ec3ef15, 0x3e8483ee, 0x3e05a8a8, 0x3f2cf37b, 0x3f151d42, 0x3ef64429, 0x3ebec330
.long 0x3f51b3f3, 0x3f407893, 0x3f2cf37b, 0x3f176012, 0x3f6c835e, 0x3f61c598, 0x3f54db31, 0x3f45e403
.long 0x00000000, 0x00000000, 0x00000000, 0x00000000, 0x3e8483ee, 0x3e89e6f1, 0x3e8f45c0, 0x3e94a031
.long 0x3f000000, 0x3f04ce53, 0x3f098c78, 0x3f0e39da, 0x3f3504f3, 0x3f3ad85f, 0x3f407893, 0x3f45e403
.long 0x3f800000, 0x3f7f73af, 0x3f7dcf55, 0x3f7b14be, 0x3f7746ea, 0x3f7a8575, 0x3f7d0543, 0x3f7ec46d
.long 0x3f5db3d7, 0x3f631324, 0x3f6803ca, 0x3f6c835e, 0x3f3504f3, 0x3f3ad85f, 0x3f407893, 0x3f45e403
.long 0x3f800000, 0x3f7f73af, 0x3f7dcf55, 0x3f7b14be, 0x3f7746ea, 0x3f718088, 0x3f6a51da, 0x3f61c598
.long 0x3f5db3d7, 0x3f51b3f3, 0x3f441b7d, 0x3f3504f3, 0x3f3504f3, 0x3f226799, 0x3f0e39da, 0x3ef15aea
.long 0x00000000, 0xbe05a8a8, 0xbe8483ee, 0xbec3ef15, 0x3e8483ee, 0x3e10b9a6, 0x3cb2b521, 0xbdc8bd36
.long 0x3f000000, 0x3ece34d0, 0x3e99f61c, 0x3e47c5c2, 0x3f3504f3, 0x3f226799, 0x3f0e39da, 0x3ef15aea
.long 0x00000000, 0x00000000, 0x00000000, 0x00000000, 0x3e99f61c, 0x3e9f4757, 0x3ea493b7, 0x3ea9db13
.long 0x3f12d5e8, 0x3f176012, 0x3f1bd7ca, 0x3f203c85, 0x3f4b1934, 0x3f5016b8, 0x3f54db31, 0x3f596550
.long 0x3f7746ea, 0x3f726a03, 0x3f6c835e, 0x3f659974, 0x3f7fc1a0, 0x3f7ffc1a, 0x3f7f73af, 0x3f7e28c6
.long 0x3f708fb2, 0x3f7426cb, 0x3f7746ea, 0x3f79ee89, 0x3f4b1934, 0x3f5016b8, 0x3f54db31, 0x3f596550
.long 0x3f7746ea, 0x3f726a03, 0x3f6c835e, 0x3f659974, 0x3f57e880, 0x3f4cc94c, 0x3f407893, 0x3f3308b4
.long 0x3f248dbb, 0x3f12d5e8, 0x3f000000, 0x3ed8616c, 0x3ec3ef15, 0x3e94a031, 0x3e47c5c2, 0x3dc8bd36
.long 0xbf000000, 0xbf1bd7ca, 0xbf3504f3, 0xbf4b1934, 0xbe5da259, 0xbea9db13, 0xbee273aa, 0xbf0be54a
.long 0x3db27eb6, 0xbcb2b521, 0xbe05a8a8, 0xbe7363ee, 0x3ec3ef15, 0x3e94a031, 0x3e47c5c2, 0x3dc8bd36
.long 0x00000000, 0x00000000, 0x00000000, 0x00000000, 0x3eaf1d44, 0x3eb45a1e, 0x3eb9917b, 0x3ebec330
.long 0x3f248dbb, 0x3f28cae3, 0x3f2cf37b, 0x3f310700, 0x3f5db3d7, 0x3f61c598, 0x3f659974, 0x3f692e5f
.long 0x3f5db3d7, 0x3f54db31, 0x3f4b1934, 0x3f407893, 0x3f7c1c5c, 0x3f795000, 0x3f75c5d4, 0x3f718088
.long 0x3f7c1c5c, 0x3f7dcf55, 0x3f7f069e, 0x3f7fc1a0, 0x3f5db3d7, 0x3f61c598, 0x3f659974, 0x3f692e5f
.long 0x3f5db3d7, 0x3f54db31, 0x3f4b1934, 0x3f407893, 0x3f248dbb, 0x3f151d42, 0x3f04ce53, 0x3ee77284
.long 0x3eaf1d44, 0x3e8483ee, 0x3e31d0d4, 0x3db27eb6, 0x00000000, 0xbdc8bd36, 0xbe47c5c2, 0xbe94a031
.long 0xbf5db3d7, 0xbf6c835e, 0xbf7746ea, 0xbf7dcf55, 0xbf248dbb, 0xbf3ad85f, 0xbf4e7327, 0xbf5f15e7
.long 0xbeaf1d44, 0xbee273aa, 0xbf098c78, 0xbf203c85, 0x00000000, 0xbdc8bd36, 0xbe47c5c2, 0xbe94a031
.long 0x00000000, 0x00000000, 0x00000000, 0x00000000, 0x3ec3ef15, 0x3ec91503, 0x3ece34d0, 0x3ed34e56
.long 0x3f3504f3, 0x3f38ecd8, 0x3f3cbe35, 0x3f407893, 0x3f6c835e, 0x3f6f9788, 0x3f726a03, 0x3f74fa0b
.long 0x3f3504f3, 0x3f28cae3, 0x3f1bd7ca, 0x3f0e39da, 0x3f6c835e, 0x3f66d223, 0x3f60712a, 0x3f596550
.long 0x3f800000, 0x3f7fc1a0, 0x3f7f069e, 0x3f7dcf55, 0x3f6c835e, 0x3f6f9788, 0x3f726a03, 0x3f74fa0b
.long 0x3f3504f3, 0x3f28cae3, 0x3f1bd7ca, 0x3f0e39da, 0x3ec3ef15, 0x3e9f4757, 0x3e7363ee, 0x3e26ce12
.long 0x00000000, 0xbdb27eb6, 0xbe31d0d4, 0xbe8483ee, 0xbec3ef15, 0xbef15aea, 0xbf0e39da, 0xbf226799
.long 0xbf800000, 0xbf7dcf55, 0xbf7746ea, 0xbf6c835e, 0xbf6c835e, 0xbf768a20, 0xbf7d0543, 0xbf7fdce9
.long 0xbf3504f3, 0xbf47a682, 0xbf57e880, 0xbf659974, 0xbec3ef15, 0xbef15aea, 0xbf0e39da, 0xbf226799
.long 0x00000000, 0x00000000, 0x00000000, 0x00000000, 0x3ed8616c, 0x3edd6dea, 0x3ee273aa, 0x3ee77284
.long 0x3f441b7d, 0x3f47a682, 0x3f4b1934, 0x3f4e7327, 0x3f7746ea, 0x3f795000, 0x3f7b14be, 0x3f7c94a8
.long 0x3f000000, 0x3ee273aa, 0x3ec3ef15, 0x3ea493b7, 0x3f51b3f3, 0x3f4962ed, 0x3f407893, 0x3f36fbaf
.long 0x3f7c1c5c, 0x3f79ee89, 0x3f7746ea, 0x3f7426cb, 0x3f7746ea, 0x3f795000, 0x3f7b14be, 0x3f7c94a8
.long 0x3f000000, 0x3ee273aa, 0x3ec3ef15, 0x3ea493b7, 0x3db27eb6, 0x3c32b7da, 0xbd85f213, 0xbe10b9a6
.long 0xbeaf1d44, 0xbed8616c, 0xbf000000, 0xbf12d5e8, 0xbf3504f3, 0xbf45e403, 0xbf54db31, 0xbf61c598
.long 0xbf5db3d7, 0xbf4b1934, 0xbf3504f3, 0xbf1bd7ca, 0xbf7f069e, 0xbf7a8575, 0xbf726a03, 0xbf66d223
.long 0xbf708fb2, 0xbf78a9e0, 0xbf7dcf55, 0xbf7ff067, 0xbf3504f3, 0xbf45e403, 0xbf54db31, 0xbf61c598
.long 0x00000000, 0x00000000, 0x00000000, 0x00000000, 0x3eec6a50, 0x3ef15aea, 0x3ef64429, 0x3efb25e8
.long 0x3f51b3f3, 0x3f54db31, 0x3f57e880, 0x3f5adb81, 0x3f7dcf55, 0x3f7ec46d, 0x3f7f73af, 0x3f7fdce9
.long 0x3e8483ee, 0x3e47c5c2, 0x3e05a8a8, 0x3d85f213, 0x3f2cf37b, 0x3f226799, 0x3f176012, 0x3f0be54a
.long 0x3f708fb2, 0x3f6c835e, 0x3f6803ca, 0x3f631324, 0x3f7dcf55, 0x3f7ec46d, 0x3f7f73af, 0x3f7fdce9
.long 0x3e8483ee, 0x3e47c5c2, 0x3e05a8a8, 0x3d85f213, 0xbe5da259, 0xbe94a031, 0xbeb9917b, 0xbedd6dea
.long 0xbf248dbb, 0xbf3504f3, 0xbf441b7d, 0xbf51b3f3, 0xbf6c835e, 0xbf74fa0b, 0xbf7b14be, 0xbf7ec46d
.long 0xbf000000, 0xbec3ef15, 0xbe8483ee, 0xbe05a8a8, 0xbf57e880, 0xbf45e403, 0xbf310700, 0xbf199e45
.long 0xbf7f069e, 0xbf7b14be, 0xbf7426cb, 0xbf6a51da, 0xbf6c835e, 0xbf74fa0b, 0xbf7b14be, 0xbf7ec46d
.long 0x00003f80, 0x00003f80, 0x00003f80, 0x00003f80, 0x00003f80, 0x3e063f7e, 0x3e853f77, 0x3ec43f6d
.long 0x00003f80, 0x3e853f77, 0x3f003f5e, 0x3f353f35, 0x00003f80, 0x3ec43f6d, 0x3f353f35, 0x3f6d3ec4
.long 0x00003f80, 0x3f003f5e, 0x3f5e3f00, 0x3f800000, 0x00003f80, 0x3f1c3f4b, 0x3f773e85, 0x3f6dbec4
.long 0x00003f80, 0x3f353f35, 0x3f800000, 0x3f35bf35, 0x00003f80, 0x3f4b3f1c, 0x3f77be85, 0x3ec4bf6d
.long 0x00003f80, 0x3f5e3f00, 0x3f5ebf00, 0x0000bf80, 0x00003f80, 0x3f6d3ec4, 0x3f35bf35, 0xbec4bf6d
.long 0x00003f80, 0x3f773e85, 0x3f00bf5e, 0xbf35bf35, 0x00003f80, 0x3f7e3e06, 0x3e85bf77, 0xbf6dbec4
.long 0x00003f80, 0x3f800000, 0x0000bf80, 0xbf800000, 0x00003f80, 0x3f7ebe06, 0xbe85bf77, 0xbf6d3ec4
.long 0x00003f80, 0x3f77be85, 0xbf00bf5e, 0xbf353f35, 0x00003f80, 0x3f6dbec4, 0xbf35bf35, 0xbec43f6d
.long 0x00003f80, 0x00003f80, 0x00003f80, 0x00003f80, 0x3f003f5e, 0x3f1c3f4b, 0x3f353f35, 0x3f4b3f1c
.long 0x3f5e3f00, 0x3f773e85, 0x3f800000, 0x3f77be85, 0x3f800000, 0x3f6dbec4, 0x3f35bf35, 0x3ec4bf6d
.long 0x3f5ebf00, 0x3f00bf5e, 0x0000bf80, 0xbf00bf5e, 0x3f00bf5e, 0xbe06bf7e, 0xbf35bf35, 0xbf7ebe06
.long 0x0000bf80, 0xbf35bf35, 0xbf800000, 0xbf353f35, 0xbf00bf5e, 0xbf7ebe06, 0xbf353f35, 0x3e063f7e
.long 0xbf5ebf00, 0xbf5e3f00, 0x00003f80, 0x3f5e3f00, 0xbf800000, 0xbec43f6d, 0x3f353f35, 0x3f6dbec4
.long 0xbf5e3f00, 0x3e853f77, 0x3f800000, 0x3e85bf77, 0xbf003f5e, 0x3f4b3f1c, 0x3f35bf35, 0xbf1cbf4b
.long 0x00003f80, 0x3f800000, 0x0000bf80, 0xbf800000, 0x3f003f5e, 0x3f4bbf1c, 0xbf35bf35, 0xbf1c3f4b
.long 0x3f5e3f00, 0x3e85bf77, 0xbf800000, 0x3e853f77, 0x3f800000, 0xbec4bf6d, 0xbf353f35, 0x3f6d3ec4
.long 0x00003f80, 0x00003f80, 0x00003f80, 0x00003f80, 0x3f5e3f00, 0x3f6d3ec4, 0x3f773e85, 0x3f7e3e06
.long 0x3f5ebf00, 0x3f35bf35, 0x3f00bf5e, 0x3e85bf77, 0x0000bf80, 0xbec4bf6d, 0xbf35bf35, 0xbf6dbec4
.long 0xbf5ebf00, 0xbf800000, 0xbf5e3f00, 0xbf003f5e, 0xbf5e3f00, 0xbec43f6d, 0x3e853f77, 0x3f4b3f1c
.long 0x00003f80, 0x3f353f35, 0x3f800000, 0x3f35bf35, 0x3f5e3f00, 0x3f6dbec4, 0x3e85bf77, 0xbf1cbf4b
.long 0x3f5ebf00, 0x0000bf80, 0xbf5ebf00, 0xbf5e3f00, 0x0000bf80, 0xbf6dbec4, 0xbf353f35, 0x3ec43f6d
.long 0xbf5ebf00, 0xbf353f35, 0x3f003f5e, 0x3f77be85, 0xbf5e3f00, 0x3ec43f6d, 0x3f77be85, 0xbe06bf7e
.long 0x00003f80, 0x3f800000, 0x0000bf80, 0xbf800000, 0x3f5e3f00, 0x3ec4bf6d, 0xbf77be85, 0xbe063f7e
.long 0x3f5ebf00, 0xbf35bf35, 0xbf003f5e, 0x3f773e85, 0x0000bf80, 0xbf6d3ec4, 0x3f353f35, 0x3ec4bf6d
.long 0x00003f80, 0x00003f80, 0x00003f80, 0x00003f80, 0x3f800000, 0x3f7ebe06, 0x3f77be85, 0x3f6dbec4
.long 0x0000bf80, 0xbe85bf77, 0xbf00bf5e, 0xbf35bf35, 0xbf800000, 0xbf6d3ec4, 0xbf353f35, 0xbec43f6d
.long 0x00003f80, 0x3f003f5e, 0x3f5e3f00, 0x3f800000, 0x3f800000, 0x3f4bbf1c, 0x3e85bf77, 0xbec4bf6d
.long 0x0000bf80, 0xbf35bf35, 0xbf800000, 0xbf353f35, 0xbf800000, 0xbf1c3f4b, 0x3e853f77, 0x3f6d3ec4
.long 0x00003f80, 0x3f5e3f00, 0x3f5ebf00, 0x0000bf80, 0x3f800000, 0x3ec4bf6d, 0xbf35bf35, 0xbf6d3ec4
.long 0x0000bf80, 0xbf77be85, 0xbf003f5e, 0x3f353f35, 0xbf800000, 0xbe063f7e, 0x3f773e85, 0x3ec4bf6d
.long 0x00003f80, 0x3f800000, 0x0000bf80, 0xbf800000, 0x3f800000, 0xbe06bf7e, 0xbf773e85, 0x3ec43f6d
.long 0x0000bf80, 0xbf773e85, 0x3f003f5e, 0x3f35bf35, 0xbf800000, 0x3ec43f6d, 0x3f35bf35, 0xbf6dbec4
.long 0x00003f80, 0x3f5ebf00, 0xbf5ebf00, 0x00003f80, 0x00003f80, 0x3f4bbf1c, 0xbf77be85, 0x3ec43f6d
.long 0x00003f80, 0x3f35bf35, 0xbf800000, 0x3f353f35, 0x00003f80, 0x3f1cbf4b, 0xbf773e85, 0x3f6d3ec4
.long 0x00003f80, 0x3f00bf5e, 0xbf5e3f00, 0x3f800000, 0x00003f80, 0x3ec4bf6d, 0xbf353f35, 0x3f6dbec4
.long 0x00003f80, 0x3e85bf77, 0xbf003f5e, 0x3f35bf35, 0x00003f80, 0x3e06bf7e, 0xbe853f77, 0x3ec4bf6d
.long 0x00003f80, 0x0000bf80, 0x00003f80, 0x0000bf80, 0x00003f80, 0xbe06bf7e, 0x3e853f77, 0xbec4bf6d
.long 0x00003f80, 0xbe85bf77, 0x3f003f5e, 0xbf35bf35, 0x00003f80, 0xbec4bf6d, 0x3f353f35, 0xbf6dbec4
.long 0x00003f80, 0xbf00bf5e, 0x3f5e3f00, 0xbf800000, 0x00003f80, 0xbf1cbf4b, 0x3f773e85, 0xbf6d3ec4
.long 0x00003f80, 0xbf35bf35, 0x3f800000, 0xbf353f35, 0x00003f80, 0xbf4bbf1c, 0x3f77be85, 0xbec43f6d
.long 0x3f5ebf00, 0xbf5ebf00, 0x00003f80, 0x3f5ebf00, 0x3f00bf5e, 0xbf7e3e06, 0x3f353f35, 0x3e06bf7e
.long 0x0000bf80, 0xbf353f35, 0x3f800000, 0xbf35bf35, 0xbf00bf5e, 0xbe063f7e, 0x3f35bf35, 0xbf7e3e06
.long 0xbf5ebf00, 0x3f003f5e, 0x0000bf80, 0xbf003f5e, 0xbf800000, 0x3f6d3ec4, 0xbf35bf35, 0x3ec43f6d
.long 0xbf5e3f00, 0x3f77be85, 0xbf800000, 0x3f773e85, 0xbf003f5e, 0x3f1cbf4b, 0xbf353f35, 0x3f4bbf1c
.long 0x00003f80, 0x0000bf80, 0x00003f80, 0x0000bf80, 0x3f003f5e, 0xbf1cbf4b, 0x3f353f35, 0xbf4bbf1c
.long 0x3f5e3f00, 0xbf77be85, 0x3f800000, 0xbf773e85, 0x3f800000, 0xbf6d3ec4, 0x3f35bf35, 0xbec43f6d
.long 0x3f5ebf00, 0xbf003f5e, 0x0000bf80, 0x3f003f5e, 0x3f00bf5e, 0x3e063f7e, 0xbf35bf35, 0x3f7e3e06
.long 0x0000bf80, 0x3f353f35, 0xbf800000, 0x3f35bf35, 0xbf00bf5e, 0x3f7e3e06, 0xbf353f35, 0xbe06bf7e
.long 0xbf5ebf00, 0x00003f80, 0x3f5ebf00, 0xbf5ebf00, 0xbf5e3f00, 0x3f6d3ec4, 0xbe85bf77, 0xbf1c3f4b
.long 0x00003f80, 0x3f35bf35, 0xbf800000, 0x3f353f35, 0x3f5e3f00, 0xbec4bf6d, 0xbe853f77, 0x3f4bbf1c
.long 0x3f5ebf00, 0xbf800000, 0x3f5e3f00, 0xbf00bf5e, 0x0000bf80, 0xbec43f6d, 0x3f35bf35, 0xbf6d3ec4
.long 0xbf5ebf00, 0x3f353f35, 0xbf00bf5e, 0x3e853f77, 0xbf5e3f00, 0x3f6dbec4, 0xbf773e85, 0x3f7ebe06
.long 0x00003f80, 0x0000bf80, 0x00003f80, 0x0000bf80, 0x3f5e3f00, 0xbf6dbec4, 0x3f773e85, 0xbf7ebe06
.long 0x3f5ebf00, 0xbf353f35, 0x3f00bf5e, 0xbe853f77, 0x0000bf80, 0x3ec43f6d, 0xbf35bf35, 0x3f6d3ec4
.long 0xbf5ebf00, 0x3f800000, 0xbf5e3f00, 0x3f00bf5e, 0xbf5e3f00, 0x3ec4bf6d, 0x3e853f77, 0xbf4bbf1c
.long 0x00003f80, 0xbf35bf35, 0x3f800000, 0xbf353f35, 0x3f5e3f00, 0xbf6d3ec4, 0x3e85bf77, 0x3f1c3f4b
.long 0x00003f80, 0x3f5ebf00, 0xbf5ebf00, 0x00003f80, 0x3f800000, 0xbf1cbf4b, 0xbe853f77, 0x3f6dbec4
.long 0x0000bf80, 0xbf353f35, 0x3f800000, 0xbf35bf35, 0xbf800000, 0x3f4b3f1c, 0xbe85bf77, 0xbec43f6d
.long 0x00003f80, 0x3f00bf5e, 0xbf5e3f00, 0x3f800000, 0x3f800000, 0xbf6dbec4, 0x3f353f35, 0xbec4bf6d
.long 0x0000bf80, 0xbe853f77, 0x3f00bf5e, 0xbf353f35, 0xbf800000, 0x3f7e3e06, 0xbf77be85, 0x3f6d3ec4
.long 0x00003f80, 0x0000bf80, 0x00003f80, 0x0000bf80, 0x3f800000, 0xbf7e3e06, 0x3f77be85, 0xbf6d3ec4
.long 0x0000bf80, 0x3e853f77, 0xbf00bf5e, 0x3f353f35, 0xbf800000, 0x3f6dbec4, 0xbf353f35, 0x3ec4bf6d
.long 0x00003f80, 0xbf00bf5e, 0x3f5e3f00, 0xbf800000, 0x3f800000, 0xbf4b3f1c, 0x3e85bf77, 0x3ec43f6d
.long 0x0000bf80, 0x3f353f35, 0xbf800000, 0x3f35bf35, 0xbf800000, 0x3f1cbf4b, 0x3e853f77, 0xbf6dbec4
.long 0x00003f80, 0xbf5ebf00, 0x3f5ebf00, 0x00003f80, 0x00003f80, 0xbf6dbec4, 0x3f35bf35, 0x3ec43f6d
.long 0x00003f80, 0xbf77be85, 0x3f00bf5e, 0x3f353f35, 0x00003f80, 0xbf7ebe06, 0x3e85bf77, 0x3f6d3ec4
.long 0x00003f80, 0xbf800000, 0x0000bf80, 0x3f800000, 0x00003f80, 0xbf7e3e06, 0xbe85bf77, 0x3f6dbec4
.long 0x00003f80, 0xbf773e85, 0xbf00bf5e, 0x3f35bf35, 0x00003f80, 0xbf6d3ec4, 0xbf35bf35, 0x3ec4bf6d
.long 0x00003f80, 0xbf5e3f00, 0xbf5ebf00, 0x0000bf80, 0x00003f80, 0xbf4b3f1c, 0xbf77be85, 0xbec4bf6d
.long 0x00003f80, 0xbf353f35, 0xbf800000, 0xbf35bf35, 0x00003f80, 0xbf1c3f4b, 0xbf773e85, 0xbf6dbec4
.long 0x00003f80, 0xbf003f5e, 0xbf5e3f00, 0xbf800000, 0x00003f80, 0xbec43f6d, 0xbf353f35, 0xbf6d3ec4
.long 0x00003f80, 0xbe853f77, 0xbf003f5e, 0xbf353f35, 0x00003f80, 0xbe063f7e, 0xbe853f77, 0xbec43f6d
.long 0xbf5ebf00, 0x3f5ebf00, 0x00003f80, 0xbf5ebf00, 0xbf800000, 0x3ec4bf6d, 0x3f353f35, 0xbf6d3ec4
.long 0xbf5e3f00, 0xbe85bf77, 0x3f800000, 0xbe853f77, 0xbf003f5e, 0xbf4bbf1c, 0x3f35bf35, 0x3f1c3f4b
.long 0x00003f80, 0xbf800000, 0x0000bf80, 0x3f800000, 0x3f003f5e, 0xbf4b3f1c, 0xbf35bf35, 0x3f1cbf4b
.long 0x3f5e3f00, 0xbe853f77, 0xbf800000, 0xbe85bf77, 0x3f800000, 0x3ec43f6d, 0xbf353f35, 0xbf6dbec4
.long 0x3f5ebf00, 0x3f5e3f00, 0x00003f80, 0xbf5e3f00, 0x3f00bf5e, 0x3f7ebe06, 0x3f353f35, 0xbe063f7e
.long 0x0000bf80, 0x3f35bf35, 0x3f800000, 0x3f353f35, 0xbf00bf5e, 0x3e06bf7e, 0x3f35bf35, 0x3f7ebe06
.long 0xbf5ebf00, 0xbf00bf5e, 0x0000bf80, 0x3f00bf5e, 0xbf800000, 0xbf6dbec4, 0xbf35bf35, 0xbec4bf6d
.long 0xbf5e3f00, 0xbf773e85, 0xbf800000, 0xbf77be85, 0xbf003f5e, 0xbf1c3f4b, 0xbf353f35, 0xbf4b3f1c
.long 0x3f5ebf00, 0x00003f80, 0xbf5ebf00, 0x3f5ebf00, 0x0000bf80, 0x3f6d3ec4, 0xbf353f35, 0xbec4bf6d
.long 0xbf5ebf00, 0x3f35bf35, 0x3f003f5e, 0xbf773e85, 0xbf5e3f00, 0xbec4bf6d, 0x3f77be85, 0x3e063f7e
.long 0x00003f80, 0xbf800000, 0x0000bf80, 0x3f800000, 0x3f5e3f00, 0xbec43f6d, 0xbf77be85, 0x3e06bf7e
.long 0x3f5ebf00, 0x3f353f35, 0xbf003f5e, 0xbf77be85, 0x0000bf80, 0x3f6dbec4, 0x3f353f35, 0xbec43f6d
.long 0xbf5ebf00, 0x0000bf80, 0x3f5ebf00, 0x3f5e3f00, 0xbf5e3f00, 0xbf6dbec4, 0xbe85bf77, 0x3f1cbf4b
.long 0x00003f80, 0xbf353f35, 0xbf800000, 0xbf35bf35, 0x3f5e3f00, 0x3ec43f6d, 0xbe853f77, 0xbf4b3f1c
.long 0x3f5ebf00, 0x3f800000, 0x3f5e3f00, 0x3f003f5e, 0x0000bf80, 0x3ec4bf6d, 0x3f35bf35, 0x3f6dbec4
.long 0xbf5ebf00, 0xbf35bf35, 0xbf00bf5e, 0xbe85bf77, 0xbf5e3f00, 0xbf6d3ec4, 0xbf773e85, 0xbf7e3e06
.long 0x00003f80, 0xbf5ebf00, 0x3f5ebf00, 0x00003f80, 0x3f800000, 0xbec43f6d, 0xbf35bf35, 0x3f6dbec4
.long 0x0000bf80, 0x3f773e85, 0xbf003f5e, 0xbf35bf35, 0xbf800000, 0x3e06bf7e, 0x3f773e85, 0xbec43f6d
.long 0x00003f80, 0xbf800000, 0x0000bf80, 0x3f800000, 0x3f800000, 0x3e063f7e, 0xbf773e85, 0xbec4bf6d
.long 0x0000bf80, 0x3f77be85, 0x3f003f5e, 0xbf353f35, 0xbf800000, 0xbec4bf6d, 0x3f35bf35, 0x3f6d3ec4
.long 0x00003f80, 0xbf5e3f00, 0xbf5ebf00, 0x0000bf80, 0x3f800000, 0x3f1c3f4b, 0xbe853f77, 0xbf6d3ec4
.long 0x0000bf80, 0x3f35bf35, 0x3f800000, 0x3f353f35, 0xbf800000, 0xbf4bbf1c, 0xbe85bf77, 0x3ec4bf6d
.long 0x00003f80, 0xbf003f5e, 0xbf5e3f00, 0xbf800000, 0x3f800000, 0x3f6d3ec4, 0x3f353f35, 0x3ec43f6d
.long 0x0000bf80, 0x3e85bf77, 0x3f00bf5e, 0x3f35bf35, 0xbf800000, 0xbf7ebe06, 0xbf77be85, 0xbf6dbec4
.long 0x00003f80, 0x00003f80, 0x00003f80, 0x00003f80, 0x3f5ebf00, 0x3f4bbf1c, 0x3f35bf35, 0x3f1cbf4b
.long 0xbf5ebf00, 0xbf77be85, 0xbf800000, 0xbf773e85, 0x00003f80, 0x3ec43f6d, 0x3f353f35, 0x3f6d3ec4
.long 0x3f5ebf00, 0x3f00bf5e, 0x0000bf80, 0xbf00bf5e, 0xbf5ebf00, 0xbf7e3e06, 0xbf353f35, 0xbe063f7e
.long 0x00003f80, 0x3f353f35, 0x3f800000, 0x3f35bf35, 0x3f5ebf00, 0x3e06bf7e, 0xbf35bf35, 0xbf7e3e06
.long 0xbf5ebf00, 0xbf5e3f00, 0x00003f80, 0x3f5e3f00, 0x00003f80, 0x3f6d3ec4, 0x3f35bf35, 0xbec4bf6d
.long 0x3f5ebf00, 0xbe85bf77, 0xbf800000, 0xbe853f77, 0xbf5ebf00, 0xbf1c3f4b, 0x3f353f35, 0x3f4bbf1c
.long 0x00003f80, 0x3f800000, 0x0000bf80, 0xbf800000, 0x3f5ebf00, 0xbf1cbf4b, 0xbf353f35, 0x3f4b3f1c
.long 0xbf5ebf00, 0xbe853f77, 0x3f800000, 0xbe85bf77, 0x00003f80, 0x3f6dbec4, 0xbf35bf35, 0xbec43f6d
.long 0x00003f80, 0x00003f80, 0x00003f80, 0x00003f80, 0x3f00bf5e, 0x3ec4bf6d, 0x3e85bf77, 0x3e06bf7e
.long 0xbf5e3f00, 0xbf353f35, 0xbf003f5e, 0xbe853f77, 0x3f800000, 0x3f6dbec4, 0x3f35bf35, 0x3ec4bf6d
.long 0xbf5ebf00, 0xbf800000, 0xbf5e3f00, 0xbf003f5e, 0x3f003f5e, 0x3f6d3ec4, 0x3f77be85, 0x3f1cbf4b
.long 0x0000bf80, 0xbf35bf35, 0xbf800000, 0xbf353f35, 0xbf003f5e, 0x3ec43f6d, 0x3f773e85, 0x3f4bbf1c
.long 0x3f5ebf00, 0x0000bf80, 0xbf5ebf00, 0xbf5e3f00, 0xbf800000, 0xbec43f6d, 0x3f353f35, 0x3f6dbec4
.long 0x3f5e3f00, 0x3f35bf35, 0xbf00bf5e, 0xbf773e85, 0xbf00bf5e, 0xbf6d3ec4, 0x3e853f77, 0x3f7ebe06
.long 0x00003f80, 0x3f800000, 0x0000bf80, 0xbf800000, 0x3f00bf5e, 0xbf6dbec4, 0xbe853f77, 0x3f7e3e06
.long 0xbf5e3f00, 0x3f353f35, 0x3f00bf5e, 0xbf77be85, 0x3f800000, 0xbec4bf6d, 0xbf353f35, 0x3f6d3ec4
.long 0x00003f80, 0x00003f80, 0x00003f80, 0x00003f80, 0x0000bf80, 0xbe06bf7e, 0xbe85bf77, 0xbec4bf6d
.long 0x00003f80, 0x3e853f77, 0x3f003f5e, 0x3f353f35, 0x0000bf80, 0xbec4bf6d, 0xbf35bf35, 0xbf6dbec4
.long 0x00003f80, 0x3f003f5e, 0x3f5e3f00, 0x3f800000, 0x0000bf80, 0xbf1cbf4b, 0xbf77be85, 0xbf6d3ec4
.long 0x00003f80, 0x3f353f35, 0x3f800000, 0x3f35bf35, 0x0000bf80, 0xbf4bbf1c, 0xbf773e85, 0xbec43f6d
.long 0x00003f80, 0x3f5e3f00, 0x3f5ebf00, 0x0000bf80, 0x0000bf80, 0xbf6dbec4, 0xbf353f35, 0x3ec43f6d
.long 0x00003f80, 0x3f773e85, 0x3f00bf5e, 0xbf35bf35, 0x0000bf80, 0xbf7ebe06, 0xbe853f77, 0x3f6d3ec4
.long 0x00003f80, 0x3f800000, 0x0000bf80, 0xbf800000, 0x0000bf80, 0xbf7e3e06, 0x3e853f77, 0x3f6dbec4
.long 0x00003f80, 0x3f77be85, 0xbf00bf5e, 0xbf353f35, 0x0000bf80, 0xbf6d3ec4, 0x3f353f35, 0x3ec4bf6d
.long 0x00003f80, 0x00003f80, 0x00003f80, 0x00003f80, 0xbf00bf5e, 0xbf1cbf4b, 0xbf35bf35, 0xbf4bbf1c
.long 0x3f5e3f00, 0x3f773e85, 0x3f800000, 0x3f77be85, 0xbf800000, 0xbf6d3ec4, 0xbf353f35, 0xbec43f6d
.long 0x3f5ebf00, 0x3f00bf5e, 0x0000bf80, 0xbf00bf5e, 0xbf003f5e, 0x3e063f7e, 0x3f353f35, 0x3f7e3e06
.long 0x0000bf80, 0xbf35bf35, 0xbf800000, 0xbf353f35, 0x3f003f5e, 0x3f7e3e06, 0x3f35bf35, 0xbe06bf7e
.long 0xbf5ebf00, 0xbf5e3f00, 0x00003f80, 0x3f5e3f00, 0x3f800000, 0x3ec4bf6d, 0xbf35bf35, 0xbf6d3ec4
.long 0xbf5e3f00, 0x3e853f77, 0x3f800000, 0x3e85bf77, 0x3f00bf5e, 0xbf4bbf1c, 0xbf353f35, 0x3f1c3f4b
.long 0x00003f80, 0x3f800000, 0x0000bf80, 0xbf800000, 0xbf00bf5e, 0xbf4b3f1c, 0x3f353f35, 0x3f1cbf4b
.long 0x3f5e3f00, 0x3e85bf77, 0xbf800000, 0x3e853f77, 0xbf800000, 0x3ec43f6d, 0x3f35bf35, 0xbf6dbec4
.long 0x3f5ebf00, 0xbf5ebf00, 0x00003f80, 0x3f5ebf00, 0xbf5ebf00, 0x3e063f7e, 0x3f35bf35, 0xbf7ebe06
.long 0x00003f80, 0x3f35bf35, 0xbf800000, 0x3f353f35, 0x3f5ebf00, 0xbf7ebe06, 0x3f353f35, 0xbe06bf7e
.long 0xbf5ebf00, 0x3f003f5e, 0x0000bf80, 0xbf003f5e, 0x00003f80, 0x3ec4bf6d, 0xbf353f35, 0x3f6dbec4
.long 0x3f5ebf00, 0xbf773e85, 0x3f800000, 0xbf77be85, 0xbf5ebf00, 0x3f4b3f1c, 0xbf35bf35, 0x3f1c3f4b
.long 0x00003f80, 0x0000bf80, 0x00003f80, 0x0000bf80, 0x3f5ebf00, 0xbf4b3f1c, 0x3f35bf35, 0xbf1c3f4b
.long 0xbf5ebf00, 0x3f773e85, 0xbf800000, 0x3f77be85, 0x00003f80, 0xbec4bf6d, 0x3f353f35, 0xbf6dbec4
.long 0x3f5ebf00, 0xbf003f5e, 0x0000bf80, 0x3f003f5e, 0xbf5ebf00, 0x3f7ebe06, 0xbf353f35, 0x3e06bf7e
.long 0x00003f80, 0xbf35bf35, 0x3f800000, 0xbf353f35, 0x3f5ebf00, 0xbe063f7e, 0xbf35bf35, 0x3f7ebe06
.long 0xbf5ebf00, 0x00003f80, 0x3f5ebf00, 0xbf5ebf00, 0x3f003f5e, 0x3ec4bf6d, 0xbf773e85, 0x3f4b3f1c
.long 0x0000bf80, 0xbf353f35, 0x3f800000, 0xbf35bf35, 0xbf003f5e, 0x3f6dbec4, 0xbf77be85, 0x3f1c3f4b
.long 0x3f5ebf00, 0xbf800000, 0x3f5e3f00, 0xbf00bf5e, 0xbf800000, 0x3f6d3ec4, 0xbf35bf35, 0x3ec43f6d
.long 0x3f5e3f00, 0xbf35bf35, 0x3f003f5e, 0xbe85bf77, 0xbf00bf5e, 0x3ec43f6d, 0xbe85bf77, 0x3e063f7e
.long 0x00003f80, 0x0000bf80, 0x00003f80, 0x0000bf80, 0x3f00bf5e, 0xbec43f6d, 0x3e85bf77, 0xbe063f7e
.long 0xbf5e3f00, 0x3f35bf35, 0xbf003f5e, 0x3e85bf77, 0x3f800000, 0xbf6d3ec4, 0x3f35bf35, 0xbec43f6d
.long 0xbf5ebf00, 0x3f800000, 0xbf5e3f00, 0x3f00bf5e, 0x3f003f5e, 0xbf6dbec4, 0x3f77be85, 0xbf1c3f4b
.long 0x0000bf80, 0x3f353f35, 0xbf800000, 0x3f35bf35, 0xbf003f5e, 0xbec4bf6d, 0x3f773e85, 0xbf4b3f1c
.long 0x00003f80, 0x3f5ebf00, 0xbf5ebf00, 0x00003f80, 0x0000bf80, 0xbf4b3f1c, 0x3f773e85, 0xbec4bf6d
.long 0x00003f80, 0x3f35bf35, 0xbf800000, 0x3f353f35, 0x0000bf80, 0xbf1c3f4b, 0x3f77be85, 0xbf6dbec4
.long 0x00003f80, 0x3f00bf5e, 0xbf5e3f00, 0x3f800000, 0x0000bf80, 0xbec43f6d, 0x3f35bf35, 0xbf6d3ec4
.long 0x00003f80, 0x3e85bf77, 0xbf003f5e, 0x3f35bf35, 0x0000bf80, 0xbe063f7e, 0x3e85bf77, 0xbec43f6d
.long 0x00003f80, 0x0000bf80, 0x00003f80, 0x0000bf80, 0x0000bf80, 0x3e063f7e, 0xbe85bf77, 0x3ec43f6d
.long 0x00003f80, 0xbe85bf77, 0x3f003f5e, 0xbf35bf35, 0x0000bf80, 0x3ec43f6d, 0xbf35bf35, 0x3f6d3ec4
.long 0x00003f80, 0xbf00bf5e, 0x3f5e3f00, 0xbf800000, 0x0000bf80, 0x3f1c3f4b, 0xbf77be85, 0x3f6dbec4
.long 0x00003f80, 0xbf35bf35, 0x3f800000, 0xbf353f35, 0x0000bf80, 0x3f4b3f1c, 0xbf773e85, 0x3ec4bf6d
.long 0x3f5ebf00, 0xbf5ebf00, 0x00003f80, 0x3f5ebf00, 0xbf003f5e, 0x3f7ebe06, 0xbf35bf35, 0xbe063f7e
.long 0x0000bf80, 0xbf353f35, 0x3f800000, 0xbf35bf35, 0x3f003f5e, 0x3e06bf7e, 0xbf353f35, 0x3f7ebe06
.long 0xbf5ebf00, 0x3f003f5e, 0x0000bf80, 0xbf003f5e, 0x3f800000, 0xbf6dbec4, 0x3f353f35, 0xbec4bf6d
.long 0xbf5e3f00, 0x3f77be85, 0xbf800000, 0x3f773e85, 0x3f00bf5e, 0xbf1c3f4b, 0x3f35bf35, 0xbf4b3f1c
.long 0x00003f80, 0x0000bf80, 0x00003f80, 0x0000bf80, 0xbf00bf5e, 0x3f1c3f4b, 0xbf35bf35, 0x3f4b3f1c
.long 0x3f5e3f00, 0xbf77be85, 0x3f800000, 0xbf773e85, 0xbf800000, 0x3f6dbec4, 0xbf353f35, 0x3ec4bf6d
.long 0x3f5ebf00, 0xbf003f5e, 0x0000bf80, 0x3f003f5e, 0xbf003f5e, 0xbe06bf7e, 0x3f353f35, 0xbf7ebe06
.long 0x0000bf80, 0x3f353f35, 0xbf800000, 0x3f35bf35, 0x3f003f5e, 0xbf7ebe06, 0x3f35bf35, 0x3e063f7e
.long 0xbf5ebf00, 0x3f5ebf00, 0x00003f80, 0xbf5ebf00, 0x00003f80, 0xbf6dbec4, 0x3f35bf35, 0x3ec43f6d
.long 0x3f5ebf00, 0x3e853f77, 0xbf800000, 0x3e85bf77, 0xbf5ebf00, 0x3f1cbf4b, 0x3f353f35, 0xbf4b3f1c
.long 0x00003f80, 0xbf800000, 0x0000bf80, 0x3f800000, 0x3f5ebf00, 0x3f1c3f4b, 0xbf353f35, 0xbf4bbf1c
.long 0xbf5ebf00, 0x3e85bf77, 0x3f800000, 0x3e853f77, 0x00003f80, 0xbf6d3ec4, 0xbf35bf35, 0x3ec4bf6d
.long 0x3f5ebf00, 0x3f5e3f00, 0x00003f80, 0xbf5e3f00, 0xbf5ebf00, 0xbe06bf7e, 0x3f35bf35, 0x3f7e3e06
.long 0x00003f80, 0xbf353f35, 0xbf800000, 0xbf35bf35, 0x3f5ebf00, 0x3f7e3e06, 0x3f353f35, 0x3e063f7e
.long 0xbf5ebf00, 0xbf00bf5e, 0x0000bf80, 0x3f00bf5e, 0x00003f80, 0xbec43f6d, 0xbf353f35, 0xbf6d3ec4
.long 0x3f5ebf00, 0x3f77be85, 0x3f800000, 0x3f773e85, 0xbf5ebf00, 0xbf4bbf1c, 0xbf35bf35, 0xbf1cbf4b
.long 0x3f5ebf00, 0x00003f80, 0xbf5ebf00, 0x3f5ebf00, 0xbf800000, 0x3ec4bf6d, 0x3f353f35, 0xbf6d3ec4
.long 0x3f5e3f00, 0xbf353f35, 0xbf00bf5e, 0x3f77be85, 0xbf00bf5e, 0x3f6dbec4, 0x3e853f77, 0xbf7e3e06
.long 0x00003f80, 0xbf800000, 0x0000bf80, 0x3f800000, 0x3f00bf5e, 0x3f6d3ec4, 0xbe853f77, 0xbf7ebe06
.long 0xbf5e3f00, 0xbf35bf35, 0x3f00bf5e, 0x3f773e85, 0x3f800000, 0x3ec43f6d, 0xbf353f35, 0xbf6dbec4
.long 0xbf5ebf00, 0x0000bf80, 0x3f5ebf00, 0x3f5e3f00, 0x3f003f5e, 0xbec43f6d, 0xbf773e85, 0xbf4bbf1c
.long 0x0000bf80, 0x3f35bf35, 0x3f800000, 0x3f353f35, 0xbf003f5e, 0xbf6d3ec4, 0xbf77be85, 0xbf1cbf4b
.long 0x3f5ebf00, 0x3f800000, 0x3f5e3f00, 0x3f003f5e, 0xbf800000, 0xbf6dbec4, 0xbf35bf35, 0xbec4bf6d
.long 0x3f5e3f00, 0x3f353f35, 0x3f003f5e, 0x3e853f77, 0xbf00bf5e, 0xbec4bf6d, 0xbe85bf77, 0xbe06bf7e
.long 0x00003f80, 0xbf5ebf00, 0x3f5ebf00, 0x00003f80, 0x0000bf80, 0x3f6d3ec4, 0xbf353f35, 0xbec4bf6d
.long 0x00003f80, 0xbf77be85, 0x3f00bf5e, 0x3f353f35, 0x0000bf80, 0x3f7e3e06, 0xbe853f77, 0xbf6dbec4
.long 0x00003f80, 0xbf800000, 0x0000bf80, 0x3f800000, 0x0000bf80, 0x3f7ebe06, 0x3e853f77, 0xbf6d3ec4
.long 0x00003f80, 0xbf773e85, 0xbf00bf5e, 0x3f35bf35, 0x0000bf80, 0x3f6dbec4, 0x3f353f35, 0xbec43f6d
.long 0x00003f80, 0xbf5e3f00, 0xbf5ebf00, 0x0000bf80, 0x0000bf80, 0x3f4bbf1c, 0x3f773e85, 0x3ec43f6d
.long 0x00003f80, 0xbf353f35, 0xbf800000, 0xbf35bf35, 0x0000bf80, 0x3f1cbf4b, 0x3f77be85, 0x3f6d3ec4
.long 0x00003f80, 0xbf003f5e, 0xbf5e3f00, 0xbf800000, 0x0000bf80, 0x3ec4bf6d, 0x3f35bf35, 0x3f6dbec4
.long 0x00003f80, 0xbe853f77, 0xbf003f5e, 0xbf353f35, 0x0000bf80, 0x3e06bf7e, 0x3e85bf77, 0x3ec4bf6d
.long 0xbf5ebf00, 0x3f5ebf00, 0x00003f80, 0xbf5ebf00, 0x3f800000, 0xbec43f6d, 0xbf35bf35, 0x3f6dbec4
.long 0xbf5e3f00, 0xbe85bf77, 0x3f800000, 0xbe853f77, 0x3f00bf5e, 0x3f4b3f1c, 0xbf353f35, 0xbf1cbf4b
.long 0x00003f80, 0xbf800000, 0x0000bf80, 0x3f800000, 0xbf00bf5e, 0x3f4bbf1c, 0x3f353f35, 0xbf1c3f4b
.long 0x3f5e3f00, 0xbe853f77, 0xbf800000, 0xbe85bf77, 0xbf800000, 0xbec4bf6d, 0x3f35bf35, 0x3f6d3ec4
.long 0x3f5ebf00, 0x3f5e3f00, 0x00003f80, 0xbf5e3f00, 0xbf003f5e, 0xbf7e3e06, 0xbf35bf35, 0x3e06bf7e
.long 0x0000bf80, 0x3f35bf35, 0x3f800000, 0x3f353f35, 0x3f003f5e, 0xbe063f7e, 0xbf353f35, 0xbf7e3e06
.long 0xbf5ebf00, 0xbf00bf5e, 0x0000bf80, 0x3f00bf5e, 0x3f800000, 0x3f6d3ec4, 0x3f353f35, 0x3ec43f6d
.long 0xbf5e3f00, 0xbf773e85, 0xbf800000, 0xbf77be85, 0x3f00bf5e, 0x3f1cbf4b, 0x3f35bf35, 0x3f4bbf1c
.long 0x00003f80, 0x00003f80, 0x00003f80, 0x00003f80, 0xbf5ebf00, 0xbf6dbec4, 0xbf77be85, 0xbf7ebe06
.long 0x3f5ebf00, 0x3f35bf35, 0x3f00bf5e, 0x3e85bf77, 0x00003f80, 0x3ec43f6d, 0x3f353f35, 0x3f6d3ec4
.long 0xbf5ebf00, 0xbf800000, 0xbf5e3f00, 0xbf003f5e, 0x3f5ebf00, 0x3ec4bf6d, 0xbe85bf77, 0xbf4bbf1c
.long 0x00003f80, 0x3f353f35, 0x3f800000, 0x3f35bf35, 0xbf5ebf00, 0xbf6d3ec4, 0xbe853f77, 0x3f1c3f4b
.long 0x3f5ebf00, 0x0000bf80, 0xbf5ebf00, 0xbf5e3f00, 0x00003f80, 0x3f6d3ec4, 0x3f35bf35, 0xbec4bf6d
.long 0xbf5ebf00, 0xbf353f35, 0x3f003f5e, 0x3f77be85, 0x3f5ebf00, 0xbec4bf6d, 0xbf773e85, 0x3e063f7e
.long 0x00003f80, 0x3f800000, 0x0000bf80, 0xbf800000, 0xbf5ebf00, 0xbec43f6d, 0x3f773e85, 0x3e06bf7e
.long 0x3f5ebf00, 0xbf35bf35, 0xbf003f5e, 0x3f773e85, 0x00003f80, 0x3f6dbec4, 0xbf35bf35, 0xbec43f6d
.long 0x00003f80, 0x00003f80, 0x00003f80, 0x00003f80, 0xbf800000, 0xbf7e3e06, 0xbf773e85, 0xbf6d3ec4
.long 0x0000bf80, 0xbe85bf77, 0xbf00bf5e, 0xbf35bf35, 0x3f800000, 0x3f6dbec4, 0x3f35bf35, 0x3ec4bf6d
.long 0x00003f80, 0x3f003f5e, 0x3f5e3f00, 0x3f800000, 0xbf800000, 0xbf4b3f1c, 0xbe853f77, 0x3ec43f6d
.long 0x0000bf80, 0xbf35bf35, 0xbf800000, 0xbf353f35, 0x3f800000, 0x3f1cbf4b, 0xbe85bf77, 0xbf6dbec4
.long 0x00003f80, 0x3f5e3f00, 0x3f5ebf00, 0x0000bf80, 0xbf800000, 0xbec43f6d, 0x3f353f35, 0x3f6dbec4
.long 0x0000bf80, 0xbf77be85, 0xbf003f5e, 0x3f353f35, 0x3f800000, 0x3e06bf7e, 0xbf77be85, 0xbec43f6d
.long 0x00003f80, 0x3f800000, 0x0000bf80, 0xbf800000, 0xbf800000, 0x3e063f7e, 0x3f77be85, 0xbec4bf6d
.long 0x0000bf80, 0xbf773e85, 0x3f003f5e, 0x3f35bf35, 0x3f800000, 0xbec4bf6d, 0xbf353f35, 0x3f6d3ec4
.long 0x00003f80, 0x00003f80, 0x00003f80, 0x00003f80, 0xbf5e3f00, 0xbf4b3f1c, 0xbf353f35, 0xbf1c3f4b
.long 0xbf5ebf00, 0xbf77be85, 0xbf800000, 0xbf773e85, 0x0000bf80, 0xbec4bf6d, 0xbf35bf35, 0xbf6dbec4
.long 0x3f5ebf00, 0x3f00bf5e, 0x0000bf80, 0xbf00bf5e, 0x3f5e3f00, 0x3f7ebe06, 0x3f35bf35, 0x3e06bf7e
.long 0x00003f80, 0x3f353f35, 0x3f800000, 0x3f35bf35, 0xbf5e3f00, 0xbe063f7e, 0x3f353f35, 0x3f7ebe06
.long 0xbf5ebf00, 0xbf5e3f00, 0x00003f80, 0x3f5e3f00, 0x0000bf80, 0xbf6dbec4, 0xbf353f35, 0x3ec43f6d
.long 0x3f5ebf00, 0xbe85bf77, 0xbf800000, 0xbe853f77, 0x3f5e3f00, 0x3f1cbf4b, 0xbf35bf35, 0xbf4b3f1c
.long 0x00003f80, 0x3f800000, 0x0000bf80, 0xbf800000, 0xbf5e3f00, 0x3f1c3f4b, 0x3f35bf35, 0xbf4bbf1c
.long 0xbf5ebf00, 0xbe853f77, 0x3f800000, 0xbe85bf77, 0x0000bf80, 0xbf6d3ec4, 0x3f353f35, 0x3ec4bf6d
.long 0x00003f80, 0x00003f80, 0x00003f80, 0x00003f80, 0xbf003f5e, 0xbec43f6d, 0xbe853f77, 0xbe063f7e
.long 0xbf5e3f00, 0xbf353f35, 0xbf003f5e, 0xbe853f77, 0xbf800000, 0xbf6d3ec4, 0xbf353f35, 0xbec43f6d
.long 0xbf5ebf00, 0xbf800000, 0xbf5e3f00, 0xbf003f5e, 0xbf00bf5e, 0xbf6dbec4, 0xbf773e85, 0xbf1c3f4b
.long 0x0000bf80, 0xbf35bf35, 0xbf800000, 0xbf353f35, 0x3f00bf5e, 0xbec4bf6d, 0xbf77be85, 0xbf4b3f1c
.long 0x3f5ebf00, 0x0000bf80, 0xbf5ebf00, 0xbf5e3f00, 0x3f800000, 0x3ec4bf6d, 0xbf35bf35, 0xbf6d3ec4
.long 0x3f5e3f00, 0x3f35bf35, 0xbf00bf5e, 0xbf773e85, 0x3f003f5e, 0x3f6dbec4, 0xbe85bf77, 0xbf7e3e06
.long 0x00003f80, 0x3f800000, 0x0000bf80, 0xbf800000, 0xbf003f5e, 0x3f6d3ec4, 0x3e85bf77, 0xbf7ebe06
.long 0xbf5e3f00, 0x3f353f35, 0x3f00bf5e, 0xbf77be85, 0xbf800000, 0x3ec43f6d, 0x3f35bf35, 0xbf6dbec4
.long 0xbf5ebf00, 0x00003f80, 0x3f5ebf00, 0xbf5ebf00, 0x3f5ebf00, 0xbf6dbec4, 0x3e853f77, 0x3f1cbf4b
.long 0x00003f80, 0x3f35bf35, 0xbf800000, 0x3f353f35, 0xbf5ebf00, 0x3ec43f6d, 0x3e85bf77, 0xbf4b3f1c
.long 0x3f5ebf00, 0xbf800000, 0x3f5e3f00, 0xbf00bf5e, 0x00003f80, 0x3ec4bf6d, 0xbf353f35, 0x3f6dbec4
.long 0xbf5ebf00, 0x3f353f35, 0xbf00bf5e, 0x3e853f77, 0x3f5ebf00, 0xbf6d3ec4, 0x3f77be85, 0xbf7e3e06
.long 0x00003f80, 0x0000bf80, 0x00003f80, 0x0000bf80, 0xbf5ebf00, 0x3f6d3ec4, 0xbf77be85, 0x3f7e3e06
.long 0x3f5ebf00, 0xbf353f35, 0x3f00bf5e, 0xbe853f77, 0x00003f80, 0xbec4bf6d, 0x3f353f35, 0xbf6dbec4
.long 0xbf5ebf00, 0x3f800000, 0xbf5e3f00, 0x3f00bf5e, 0x3f5ebf00, 0xbec43f6d, 0xbe85bf77, 0x3f4b3f1c
.long 0x00003f80, 0xbf35bf35, 0x3f800000, 0xbf353f35, 0xbf5ebf00, 0x3f6dbec4, 0xbe853f77, 0xbf1cbf4b
.long 0x00003f80, 0x3f5ebf00, 0xbf5ebf00, 0x00003f80, 0xbf800000, 0x3f1c3f4b, 0x3e85bf77, 0xbf6d3ec4
.long 0x0000bf80, 0xbf353f35, 0x3f800000, 0xbf35bf35, 0x3f800000, 0xbf4bbf1c, 0x3e853f77, 0x3ec4bf6d
.long 0x00003f80, 0x3f00bf5e, 0xbf5e3f00, 0x3f800000, 0xbf800000, 0x3f6d3ec4, 0xbf35bf35, 0x3ec43f6d
.long 0x0000bf80, 0xbe853f77, 0x3f00bf5e, 0xbf353f35, 0x3f800000, 0xbf7ebe06, 0x3f773e85, 0xbf6dbec4
.long 0x00003f80, 0x0000bf80, 0x00003f80, 0x0000bf80, 0xbf800000, 0x3f7ebe06, 0xbf773e85, 0x3f6dbec4
.long 0x0000bf80, 0x3e853f77, 0xbf00bf5e, 0x3f353f35, 0x3f800000, 0xbf6d3ec4, 0x3f35bf35, 0xbec43f6d
.long 0x00003f80, 0xbf00bf5e, 0x3f5e3f00, 0xbf800000, 0xbf800000, 0x3f4bbf1c, 0xbe853f77, 0xbec4bf6d
.long 0x0000bf80, 0x3f353f35, 0xbf800000, 0x3f35bf35, 0x3f800000, 0xbf1c3f4b, 0xbe85bf77, 0x3f6d3ec4
.long 0x3f5ebf00, 0xbf5ebf00, 0x00003f80, 0x3f5ebf00, 0x3f5e3f00, 0xbe06bf7e, 0xbf353f35, 0x3f7e3e06
.long 0x00003f80, 0x3f35bf35, 0xbf800000, 0x3f353f35, 0xbf5e3f00, 0x3f7e3e06, 0xbf35bf35, 0x3e063f7e
.long 0xbf5ebf00, 0x3f003f5e, 0x0000bf80, 0xbf003f5e, 0x0000bf80, 0xbec43f6d, 0x3f35bf35, 0xbf6d3ec4
.long 0x3f5ebf00, 0xbf773e85, 0x3f800000, 0xbf77be85, 0x3f5e3f00, 0xbf4bbf1c, 0x3f353f35, 0xbf1cbf4b
.long 0x00003f80, 0x0000bf80, 0x00003f80, 0x0000bf80, 0xbf5e3f00, 0x3f4bbf1c, 0xbf353f35, 0x3f1cbf4b
.long 0xbf5ebf00, 0x3f773e85, 0xbf800000, 0x3f77be85, 0x0000bf80, 0x3ec43f6d, 0xbf35bf35, 0x3f6d3ec4
.long 0x3f5ebf00, 0xbf003f5e, 0x0000bf80, 0x3f003f5e, 0x3f5e3f00, 0xbf7e3e06, 0x3f35bf35, 0xbe063f7e
.long 0x00003f80, 0xbf35bf35, 0x3f800000, 0xbf353f35, 0xbf5e3f00, 0x3e06bf7e, 0x3f353f35, 0xbf7e3e06
.long 0xbf5ebf00, 0x00003f80, 0x3f5ebf00, 0xbf5ebf00, 0xbf00bf5e, 0xbec43f6d, 0x3f77be85, 0xbf4bbf1c
.long 0x0000bf80, 0xbf353f35, 0x3f800000, 0xbf35bf35, 0x3f00bf5e, 0xbf6d3ec4, 0x3f773e85, 0xbf1cbf4b
.long 0x3f5ebf00, 0xbf800000, 0x3f5e3f00, 0xbf00bf5e, 0x3f800000, 0xbf6dbec4, 0x3f353f35, 0xbec4bf6d
.long 0x3f5e3f00, 0xbf35bf35, 0x3f003f5e, 0xbe85bf77, 0x3f003f5e, 0xbec4bf6d, 0x3e853f77, 0xbe06bf7e
.long 0x00003f80, 0x0000bf80, 0x00003f80, 0x0000bf80, 0xbf003f5e, 0x3ec4bf6d, 0xbe853f77, 0x3e06bf7e
.long 0xbf5e3f00, 0x3f35bf35, 0xbf003f5e, 0x3e85bf77, 0xbf800000, 0x3f6dbec4, 0xbf353f35, 0x3ec4bf6d
.long 0xbf5ebf00, 0x3f800000, 0xbf5e3f00, 0x3f00bf5e, 0xbf00bf5e, 0x3f6d3ec4, 0xbf773e85, 0x3f1cbf4b
.long 0x0000bf80, 0x3f353f35, 0xbf800000, 0x3f35bf35, 0x3f00bf5e, 0x3ec43f6d, 0xbf77be85, 0x3f4bbf1c
.long 0x3f5ebf00, 0x00003f80, 0xbf5ebf00, 0x3f5ebf00, 0x00003f80, 0xbf6dbec4, 0x3f35bf35, 0x3ec43f6d
.long 0xbf5ebf00, 0x3f35bf35, 0x3f003f5e, 0xbf773e85, 0x3f5ebf00, 0x3ec43f6d, 0xbf773e85, 0xbe06bf7e
.long 0x00003f80, 0xbf800000, 0x0000bf80, 0x3f800000, 0xbf5ebf00, 0x3ec4bf6d, 0x3f773e85, 0xbe063f7e
.long 0x3f5ebf00, 0x3f353f35, 0xbf003f5e, 0xbf77be85, 0x00003f80, 0xbf6d3ec4, 0xbf35bf35, 0x3ec4bf6d
.long 0xbf5ebf00, 0x0000bf80, 0x3f5ebf00, 0x3f5e3f00, 0x3f5ebf00, 0x3f6d3ec4, 0x3e853f77, 0xbf1c3f4b
.long 0x00003f80, 0xbf353f35, 0xbf800000, 0xbf35bf35, 0xbf5ebf00, 0xbec4bf6d, 0x3e85bf77, 0x3f4bbf1c
.long 0x3f5ebf00, 0x3f800000, 0x3f5e3f00, 0x3f003f5e, 0x00003f80, 0xbec43f6d, 0xbf353f35, 0xbf6d3ec4
.long 0xbf5ebf00, 0xbf35bf35, 0xbf00bf5e, 0xbe85bf77, 0x3f5ebf00, 0x3f6dbec4, 0x3f77be85, 0x3f7ebe06
.long 0x00003f80, 0xbf5ebf00, 0x3f5ebf00, 0x00003f80, 0xbf800000, 0x3ec4bf6d, 0x3f353f35, 0xbf6d3ec4
.long 0x0000bf80, 0x3f773e85, 0xbf003f5e, 0xbf35bf35, 0x3f800000, 0xbe063f7e, 0xbf77be85, 0x3ec4bf6d
.long 0x00003f80, 0xbf800000, 0x0000bf80, 0x3f800000, 0xbf800000, 0xbe06bf7e, 0x3f77be85, 0x3ec43f6d
.long 0x0000bf80, 0x3f77be85, 0x3f003f5e, 0xbf353f35, 0x3f800000, 0x3ec43f6d, 0xbf353f35, 0xbf6dbec4
.long 0x00003f80, 0xbf5e3f00, 0xbf5ebf00, 0x0000bf80, 0xbf800000, 0xbf1cbf4b, 0x3e85bf77, 0x3f6dbec4
.long 0x0000bf80, 0x3f35bf35, 0x3f800000, 0x3f353f35, 0x3f800000, 0x3f4b3f1c, 0x3e853f77, 0xbec43f6d
.long 0x00003f80, 0xbf003f5e, 0xbf5e3f00, 0xbf800000, 0xbf800000, 0xbf6dbec4, 0xbf35bf35, 0xbec4bf6d
.long 0x0000bf80, 0x3e85bf77, 0x3f00bf5e, 0x3f35bf35, 0x3f800000, 0x3f7e3e06, 0x3f773e85, 0x3f6d3ec4
.long 0xbf5ebf00, 0x3f5ebf00, 0x00003f80, 0xbf5ebf00, 0x0000bf80, 0x3f6d3ec4, 0xbf353f35, 0xbec4bf6d
.long 0x3f5ebf00, 0x3e853f77, 0xbf800000, 0x3e85bf77, 0x3f5e3f00, 0xbf1c3f4b, 0xbf35bf35, 0x3f4bbf1c
.long 0x00003f80, 0xbf800000, 0x0000bf80, 0x3f800000, 0xbf5e3f00, 0xbf1cbf4b, 0x3f35bf35, 0x3f4b3f1c
.long 0xbf5ebf00, 0x3e85bf77, 0x3f800000, 0x3e853f77, 0x0000bf80, 0x3f6dbec4, 0x3f353f35, 0xbec43f6d
.long 0x3f5ebf00, 0x3f5e3f00, 0x00003f80, 0xbf5e3f00, 0x3f5e3f00, 0x3e063f7e, 0xbf353f35, 0xbf7ebe06
.long 0x00003f80, 0xbf353f35, 0xbf800000, 0xbf35bf35, 0xbf5e3f00, 0xbf7ebe06, 0xbf35bf35, 0xbe06bf7e
.long 0xbf5ebf00, 0xbf00bf5e, 0x0000bf80, 0x3f00bf5e, 0x0000bf80, 0x3ec4bf6d, 0x3f35bf35, 0x3f6dbec4
.long 0x3f5ebf00, 0x3f77be85, 0x3f800000, 0x3f773e85, 0x3f5e3f00, 0x3f4b3f1c, 0x3f353f35, 0x3f1c3f4b
.long 0x3f5ebf00, 0x00003f80, 0xbf5ebf00, 0x3f5ebf00, 0x3f800000, 0xbec43f6d, 0xbf35bf35, 0x3f6dbec4
.long 0x3f5e3f00, 0xbf353f35, 0xbf00bf5e, 0x3f77be85, 0x3f003f5e, 0xbf6d3ec4, 0xbe85bf77, 0x3f7ebe06
.long 0x00003f80, 0xbf800000, 0x0000bf80, 0x3f800000, 0xbf003f5e, 0xbf6dbec4, 0x3e85bf77, 0x3f7e3e06
.long 0xbf5e3f00, 0xbf35bf35, 0x3f00bf5e, 0x3f773e85, 0xbf800000, 0xbec4bf6d, 0x3f35bf35, 0x3f6d3ec4
.long 0xbf5ebf00, 0x0000bf80, 0x3f5ebf00, 0x3f5e3f00, 0xbf00bf5e, 0x3ec4bf6d, 0x3f77be85, 0x3f4b3f1c
.long 0x0000bf80, 0x3f35bf35, 0x3f800000, 0x3f353f35, 0x3f00bf5e, 0x3f6dbec4, 0x3f773e85, 0x3f1c3f4b
.long 0x3f5ebf00, 0x3f800000, 0x3f5e3f00, 0x3f003f5e, 0x3f800000, 0x3f6d3ec4, 0x3f353f35, 0x3ec43f6d
.long 0x3f5e3f00, 0x3f353f35, 0x3f003f5e, 0x3e853f77, 0x3f003f5e, 0x3ec43f6d, 0x3e853f77, 0x3e063f7e
L_tabend:
.size L_tab, L_tabend-L_tab
.section .rodata,"a"
.p2align 6
.amdhsa_kernel standalone__spectral_fnet__prompt_kernel
  .amdhsa_next_free_vgpr 256
  .amdhsa_next_free_sgpr 102
  .amdhsa_accum_offset 256
  .amdhsa_group_segment_fixed_size 0
  .amdhsa_kernarg_size 64
  .amdhsa_user_sgpr_count 2
  .amdhsa_user_sgpr_kernarg_segment_ptr 1
  .amdhsa_system_sgpr_workgroup_id_x 1
.end_amdhsa_kernel
```
